```python
import torch

def _softmax(x, axis=-1):
    return torch.softmax(x, dim=axis)

def _gelu(x):
    return torch.nn.functional.gelu(x, approximate='tanh')

def _silu(x):
    return torch.nn.functional.silu(x)

def _sigmoid(x):
    return torch.sigmoid(x)

def _layernorm(x, axis=-1, eps=1e-05):
    m = x.mean(dim=axis, keepdim=True)
    v = x.var(dim=axis, keepdim=True, unbiased=False)
    return (x - m) / torch.sqrt(v + eps)

def _scatter_add(tgt, idx, src, axis=0):
    return tgt.clone().index_add_(axis, idx, src)

def _segment_sum(src, seg, n):
    out = torch.zeros((n,) + src.shape[1:], dtype=src.dtype)
    return out.index_add_(0, seg, src)

def _pad(x, pw):
    flat = tuple((v for pair in reversed(pw) for v in pair))
    return torch.nn.functional.pad(x, flat)
kernel_name = 'adaLN_cond__sliding_block_cached__geglu_ffn__decode'

def setup_inputs():

    _w = lambda a: (lambda t: t.to(torch.bfloat16) if t.is_floating_point() else t)(torch.as_tensor(a))

    def _A_setup():
        B, Sq, D = (1, 1, 448)
        Hq, Hkv, Sk, Dh = (16, 8, 8192, 256)
        assert Hq % Hkv == 0, (Hq, Hkv)
        return {'x': _w((lambda *s: torch.randn(*s, dtype=torch.bfloat16) * 0.05)(B, Sq, D)), 'k_cache': _w((lambda *s: torch.randn(*s, dtype=torch.bfloat16) * 3.2)(B, Hkv, Sk, Dh)), 'v_cache': _w((lambda *s: torch.randn(*s, dtype=torch.bfloat16) * 0.4)(B, Hkv, Sk, Dh)), 'wq': _w((lambda *s: torch.randn(*s, dtype=torch.bfloat16) * 3.2)(D, Hq * Dh) * D ** (-0.5)), 'wo': _w((lambda *s: torch.randn(*s, dtype=torch.bfloat16) * 0.4)(Hq * Dh, D) * (Hq * Dh) ** (-0.5))}
    _A_in = _A_setup()

    def _B_setup():
        B, S, D, F = (1, 1, 448, 1792)
        return {'x': _w((lambda *s: torch.randn(*s, dtype=torch.bfloat16) * 0.05)(B, S, D)), 'w_gate': _w((lambda *s: torch.randn(*s, dtype=torch.bfloat16) * 0.05)(D, F)), 'w_up': _w((lambda *s: torch.randn(*s, dtype=torch.bfloat16) * 0.05)(D, F)), 'w_down': _w((lambda *s: torch.randn(*s, dtype=torch.bfloat16) * 0.05)(F, D))}
    _B_in = _B_setup()
    return {'A_x': _A_in['x'], 'A_k_cache': _A_in['k_cache'], 'A_v_cache': _A_in['v_cache'], 'A_wq': _A_in['wq'], 'A_wo': _A_in['wo'], 'B_x': _B_in['x'], 'B_w_gate': _B_in['w_gate'], 'B_w_up': _B_in['w_up'], 'B_w_down': _B_in['w_down'], 'c': _w((lambda *s: torch.randn(*s, dtype=torch.bfloat16) * 0.2)(1, 448) * 8.0), 'w_mod': _w((lambda *s: torch.randn(*s, dtype=torch.bfloat16) * 0.2)(448, 6 * 448) * 448 ** (-0.5) * 8.0)}

def reference(A_x, A_k_cache, A_v_cache, A_wq, A_wo, B_x, B_w_gate, B_w_up, B_w_down, c, w_mod):

    def _A_ref(x, k_cache, v_cache, wq, wo):
        B, Sq, D = x.shape
        Hq, Dh = (16, 256)
        Hkv, Sk = (k_cache.shape[1], k_cache.shape[2])
        W = min(4096, max(256, Sk // 4))
        rep = Hq // Hkv
        q = (lambda x, *d: x.permute(*d))((x @ wq).reshape(B, Sq, Hq, Dh), 0, 2, 1, 3)
        k = (lambda x, n, axis: torch.repeat_interleave(x, n, dim=axis))(k_cache[:, :, Sk - W:, :], rep, axis=1)
        v = (lambda x, n, axis: torch.repeat_interleave(x, n, dim=axis))(v_cache[:, :, Sk - W:, :], rep, axis=1)
        scores = torch.einsum('bhqd,bhkd->bhqk', q, k) * Dh ** (-0.5)
        p = _softmax(scores, axis=-1)
        o = torch.einsum('bhqk,bhkd->bhqd', p, v)
        return (lambda x, *d: x.permute(*d))(o, 0, 2, 1, 3).reshape(B, Sq, Hq * Dh) @ wo

    def _B_ref(x, w_gate, w_up, w_down):
        return _gelu(x @ w_gate) * (x @ w_up) @ w_down
    x = A_x
    mod = (_silu(c) @ w_mod).reshape(c.shape[0], 6, 1, -1)
    sa, ca, ga, sb, cb, gb = (mod[:, 0].clone(), mod[:, 1].clone(), mod[:, 2].clone(), mod[:, 3].clone(), mod[:, 4].clone(), mod[:, 5].clone())
    h = _layernorm(x, axis=-1) * (1 + ca) + sa
    x = x + ga * _A_ref(h, A_k_cache, A_v_cache, A_wq, A_wo)
    h = _layernorm(x, axis=-1) * (1 + cb) + sb
    x = x + gb * _B_ref(h, B_w_gate, B_w_up, B_w_down)
    return x
```

```asm
; @launch grid=(256,1,1) block=(512,1,1) lds=70144
.amdgcn_target "amdgcn-amd-amdhsa--gfx950"
.text
.globl adaLN_cond__sliding_block_cached__geglu_ffn__decode_kernel
.p2align 12
.p2align 8
.type adaLN_cond__sliding_block_cached__geglu_ffn__decode_kernel,@function
adaLN_cond__sliding_block_cached__geglu_ffn__decode_kernel:
    s_cmp_ge_u32 s2, 256
    s_cbranch_scc1 L_exit
    s_load_dwordx16 s[4:19], s[0:1], 0
    s_load_dwordx8 s[20:27], s[0:1], 64
    s_load_dwordx4 s[28:31], s[0:1], 96
    s_lshr_b32 s34, s2, 3
    s_cmp_lg_u32 s34, 31
    s_cbranch_scc1 L_nopf
    s_getpc_b64 s[40:41]
L_pc:
    v_lshlrev_b32 v15, 7, v0
    v_min_u32 v15, L_end-L_pc-4, v15
    global_load_dword v63, v15, s[40:41]
L_nopf:
    v_lshrrev_b32 v10, 6, v0
    v_and_b32 v1, 63, v0
    v_readfirstlane_b32 s3, v10
    v_bfe_u32 v2, v0, 4, 2
    v_and_b32 v3, 15, v0
    s_movk_i32 s96, 0x7fff
    s_and_b32 s0, s2, 7
    s_and_b32 s1, s34, 7
    v_bfe_u32 v6, v0, 3, 1
    v_bfe_u32 v7, v0, 4, 1
    v_and_b32 v8, 7, v0
    v_lshl_add_u32 v6, v6, 1, v7
    v_bfe_u32 v7, v0, 5, 1
    v_lshlrev_b32 v8, 4, v8
    s_cmp_lt_u32 s34, 16
    s_cbranch_scc1 L_X
    s_bitcmp1_b32 0xff0000, s34
    s_cbranch_scc1 L_B
L_H:
    s_mov_b32 s59, 0
    s_lshr_b32 s34, s0, 1
    s_and_b32 s35, s0, 1
    s_mul_i32 s35, s35, 7
    s_add_u32 s35, s35, s1
    s_cmp_lt_u32 s1, 7
    s_cselect_b32 s36, s3, 1
    s_cmp_lg_u32 s36, 0
    s_cbranch_scc1 L_Hoth
L_mod:
    s_mul_i32 s37, s34, 112
    s_movk_i32 s39, 5376
    v_lshrrev_b32 v27, 2, v3
    v_lshl_add_u32 v26, v3, 2, v2
    v_mad_u32_u24 v28, v6, 28, v7
    v_mad_u32_u24 v26, v27, 12, v26
    v_mad_u32_u24 v28, v28, s39, v8
    v_add_lshl_u32 v26, s37, v26, 1
    s_mul_i32 s38, s37, s39
    s_lshl_b32 s39, s35, 7
    s_add_u32 s38, s38, s39
    s_movk_i32 s39, 10752
    s_waitcnt lgkmcnt(0)
    global_load_ushort v16, v26, s[22:23]
    global_load_ushort v17, v26, s[22:23] offset:24
    s_add_u32 s44, s24, s38
    s_addc_u32 s45, s25, 0
    global_load_dwordx4 v[64:67], v28, s[44:45] nt
    v_add_u32 v28, s39, v28
    global_load_dwordx4 v[68:71], v28, s[44:45] nt
    v_add_u32 v28, s39, v28
    global_load_dwordx4 v[72:75], v28, s[44:45] nt
    v_add_u32 v28, s39, v28
    global_load_dwordx4 v[76:79], v28, s[44:45] nt
    v_add_u32 v28, s39, v28
    global_load_dwordx4 v[80:83], v28, s[44:45] nt
    v_add_u32 v28, s39, v28
    global_load_dwordx4 v[84:87], v28, s[44:45] nt
    v_add_u32 v28, s39, v28
    global_load_dwordx4 v[88:91], v28, s[44:45] nt
    v_add_u32 v28, s39, v28
    global_load_dwordx4 v[92:95], v28, s[44:45] nt
    v_add_u32 v28, s39, v28
    global_load_dwordx4 v[96:99], v28, s[44:45] nt
    v_add_u32 v28, s39, v28
    global_load_dwordx4 v[100:103], v28, s[44:45] nt
    v_add_u32 v28, s39, v28
    global_load_dwordx4 v[104:107], v28, s[44:45] nt
    v_add_u32 v28, s39, v28
    global_load_dwordx4 v[108:111], v28, s[44:45] nt
    v_add_u32 v28, s39, v28
    global_load_dwordx4 v[112:115], v28, s[44:45] nt
    v_add_u32 v28, s39, v28
    global_load_dwordx4 v[116:119], v28, s[44:45] nt
    s_branch L_mod2
L_Hoth:
    s_sub_u32 s36, s3, 2
    s_cmp_lt_u32 s1, 7
    s_cselect_b32 s36, 7, s36
    s_cmp_ge_u32 s36, 4
    s_cbranch_scc1 L_Hidle
    v_add_u32 v40, 64, v0
    v_lshlrev_b32 v40, 13, v40
    s_waitcnt lgkmcnt(0)
    s_lshr_b32 s36, s10, 7
    s_sub_u32 s36, 3, s36
    s_and_b32 s36, s36, 7
    s_lshl3_add_u32 s36, s0, s36
    s_lshl_b32 s36, s36, 7
    v_add_u32 v40, s36, v40
    global_load_dword v63, v40, s[10:11] nt
    s_branch L_Hidle
L_B:
    s_lshl3_add_u32 s97, s0, s1
    v_lshl_add_u32 v11, v3, 2, v2
    s_sub_u32 s33, s3, 1
    s_lshl_b32 s34, s33, 6
    v_add_lshl_u32 v12, v11, s34, 1
    v_lshlrev_b32 v10, 4, v1
    v_min_u32 v10, 880, v10
    v_lshl_add_u32 v13, v6, 4, v7
    v_lshl_add_u32 v13, v13, 13, v8
    s_lshl_b32 s35, s33, 19
    s_lshl_b32 s36, s97, 7
    s_add_u32 s35, s35, s36
    s_movk_i32 s36, 0x4000
    s_waitcnt lgkmcnt(0)
    s_add_u32 s40, s10, s35
    s_addc_u32 s41, s11, 0
    s_cmp_lg_u32 s3, 0
    s_cbranch_scc1 L_Bw
    global_load_dwordx4 v[16:19], v10, s[4:5]
    s_branch L_B7
L_Bw:
    global_load_ushort v20, v12, s[4:5]
    global_load_dwordx4 v[64:67], v13, s[40:41] nt
    v_add_u32 v13, s36, v13
    global_load_dwordx4 v[68:71], v13, s[40:41] nt
    v_add_u32 v13, s36, v13
    global_load_dwordx4 v[72:75], v13, s[40:41] nt
    v_add_u32 v13, s36, v13
    global_load_dwordx4 v[76:79], v13, s[40:41] nt
    v_add_u32 v13, s36, v13
    global_load_dwordx4 v[80:83], v13, s[40:41] nt
    v_add_u32 v13, s36, v13
    global_load_dwordx4 v[84:87], v13, s[40:41] nt
    v_add_u32 v13, s36, v13
    global_load_dwordx4 v[88:91], v13, s[40:41] nt
    v_add_u32 v13, s36, v13
    global_load_dwordx4 v[92:95], v13, s[40:41] nt
    s_branch L_B2
L_X:
    s_lshl_b32 s36, s0, 6
    s_add_u32 s36, s36, s34
    s_add_u32 s36, s36, 48
    s_lshl4_add_u32 s36, s36, s3
    s_lshl_b32 s36, s36, 12
    s_lshl_b32 m0, s3, 12
    s_and_b32 s37, s3, 1
    s_lshl_b32 s37, s37, 3
    v_lshrrev_b32 v14, 5, v1
    v_and_b32 v15, 31, v1
    v_bitop3_b32 v15, v15, v14, s37 bitop3:0x96
    v_lshlrev_b32 v15, 4, v15
    v_lshl_add_u32 v10, v14, 9, v15
    v_xor_b32 v11, 32, v10
    v_xor_b32 v12, 64, v10
    v_xor_b32 v13, 96, v10
    s_waitcnt lgkmcnt(0)
    s_add_u32 s40, s6, s36
    s_addc_u32 s41, s7, 0
    s_add_u32 s42, s8, s36
    s_addc_u32 s43, s9, 0
    global_load_lds_dwordx4 v10, s[40:41] offset:0 nt
    global_load_lds_dwordx4 v11, s[40:41] offset:1024 nt
    global_load_lds_dwordx4 v12, s[40:41] offset:2048 nt
    s_waitcnt vmcnt(2)
    global_load_lds_dwordx4 v13, s[40:41] offset:3072 nt
    s_add_u32 m0, m0, 32768
    s_add_u32 s40, s40, 32768
    s_addc_u32 s41, s41, 0
    global_load_lds_dwordx4 v10, s[40:41] offset:0 nt
    global_load_lds_dwordx4 v11, s[40:41] offset:1024 nt
    global_load_lds_dwordx4 v12, s[40:41] offset:2048 nt
    global_load_lds_dwordx4 v13, s[40:41] offset:3072 nt
    s_load_dword s14, s[30:31], 17408
    s_branch L_X2
L_mod2:
    s_cmp_lg_u32 s59, 0
    s_cbranch_scc1 L_mod3
    s_load_dword s14, s[30:31], 17408
L_mod3:
    v_and_b32 v4, 3, v0
    v_mul_u32_u24 v4, 0x5555, v4
    v_mov_b64 v[160:161], 0
    v_mov_b64 v[162:163], 0
    v_mov_b64 v[164:165], 0
    v_mov_b64 v[166:167], 0
    v_mov_b64 v[24:25], 0
    v_mov_b64 v[26:27], 0
    v_lshlrev_b32 v18, 5, v3
    v_lshl_add_u32 v18, v2, 4, v18
    s_lshl_b32 s46, s34, 12
    s_add_u32 s46, s46, 1704448
    s_lshl_b32 s47, s34, 13
    s_add_u32 s47, s47, 20992
    s_cmp_lt_u32 s35, 14
    s_cselect_b32 s46, s46, s47
    s_lshl_b32 s47, s35, 8
    v_add_u32 v18, s47, v18
    v_mul_u32_u24 v20, 1171, v18
    v_lshrrev_b32 v20, 20, v20
    v_lshl_add_u32 v18, v20, 7, v18
    v_add_u32 v18, s46, v18
    s_waitcnt vmcnt(14)
    v_lshlrev_b32 v16, 16, v16
    v_lshlrev_b32 v17, 16, v17
    v_mul_f32 v22, 0xbfb8aa3b, v16
    v_mul_f32 v23, 0xbfb8aa3b, v17
    v_exp_f32 v22, v22
    v_exp_f32 v23, v23
    v_add_f32 v22, 1.0, v22
    v_add_f32 v23, 1.0, v23
    v_rcp_f32 v22, v22
    v_rcp_f32 v23, v23
    v_mul_f32 v16, v16, v22
    v_mul_f32 v17, v17, v23
    v_cvt_pk_bf16_f32 v16, v16, 0
    v_cvt_pk_bf16_f32 v17, v17, 0
    s_waitcnt lgkmcnt(0)
    v_mov_b32_dpp v20, v16 row_half_mirror row_mask:0xf bank_mask:0xf
    v_mov_b32_dpp v21, v17 row_half_mirror row_mask:0xf bank_mask:0xf
    s_add_u32 s14, s14, 0x01010101
    s_lshr_b32 s28, s14, 8
    s_lshr_b32 s29, s14, 16
    s_lshr_b32 s15, s14, 24
    s_mov_b32 s22, 0x0c0c0400
    s_mov_b32 s23, 0x04000c0c
    v_mov_b32 v19, 0xff
    s_and_b32 s48, s14, 0xff
    s_sub_u32 s48, 0x80, s48
    s_and_b32 s49, s28, 0xff
    s_sub_u32 s49, 0x80, s49
    s_and_b32 s50, s29, 0xff
    s_sub_u32 s50, 0x80, s50
    s_and_b32 s51, s15, 0xff
    s_sub_u32 s51, 0x80, s51
    v_mov_b32_dpp v160, v16 quad_perm:[0,0,0,0] row_mask:0xf bank_mask:0x5
    v_mov_b32_dpp v163, v16 quad_perm:[0,0,0,0] row_mask:0xf bank_mask:0xa
    v_mov_b32_dpp v161, v20 quad_perm:[3,3,3,3] row_mask:0xf bank_mask:0xa
    v_mov_b32_dpp v162, v20 quad_perm:[3,3,3,3] row_mask:0xf bank_mask:0x5
    v_mov_b32_dpp v164, v16 quad_perm:[1,1,1,1] row_mask:0xf bank_mask:0x5
    v_mov_b32_dpp v167, v16 quad_perm:[1,1,1,1] row_mask:0xf bank_mask:0xa
    v_mov_b32_dpp v165, v20 quad_perm:[2,2,2,2] row_mask:0xf bank_mask:0xa
    v_mov_b32_dpp v166, v20 quad_perm:[2,2,2,2] row_mask:0xf bank_mask:0x5
    s_waitcnt vmcnt(12)
    v_smfmac_f32_16x16x64_bf16 v[24:27], v[160:163], v[64:71], v4
    v_mov_b32_dpp v160, v16 quad_perm:[2,2,2,2] row_mask:0xf bank_mask:0x5
    v_mov_b32_dpp v163, v16 quad_perm:[2,2,2,2] row_mask:0xf bank_mask:0xa
    v_mov_b32_dpp v161, v20 quad_perm:[1,1,1,1] row_mask:0xf bank_mask:0xa
    v_mov_b32_dpp v162, v20 quad_perm:[1,1,1,1] row_mask:0xf bank_mask:0x5
    s_waitcnt vmcnt(10)
    v_smfmac_f32_16x16x64_bf16 v[24:27], v[164:167], v[72:79], v4
    v_mov_b32_dpp v164, v16 quad_perm:[3,3,3,3] row_mask:0xf bank_mask:0x5
    v_mov_b32_dpp v167, v16 quad_perm:[3,3,3,3] row_mask:0xf bank_mask:0xa
    v_mov_b32_dpp v165, v20 quad_perm:[0,0,0,0] row_mask:0xf bank_mask:0xa
    v_mov_b32_dpp v166, v20 quad_perm:[0,0,0,0] row_mask:0xf bank_mask:0x5
    s_waitcnt vmcnt(8)
    v_smfmac_f32_16x16x64_bf16 v[24:27], v[160:163], v[80:87], v4
    v_mov_b32_dpp v160, v17 quad_perm:[1,1,1,1] row_mask:0xf bank_mask:0x5
    v_mov_b32_dpp v163, v17 quad_perm:[1,1,1,1] row_mask:0xf bank_mask:0xa
    v_mov_b32_dpp v161, v21 quad_perm:[2,2,2,2] row_mask:0xf bank_mask:0xa
    v_mov_b32_dpp v162, v21 quad_perm:[2,2,2,2] row_mask:0xf bank_mask:0x5
    s_waitcnt vmcnt(6)
    v_smfmac_f32_16x16x64_bf16 v[24:27], v[164:167], v[88:95], v4
    v_mov_b32_dpp v164, v17 quad_perm:[2,2,2,2] row_mask:0xf bank_mask:0x5
    v_mov_b32_dpp v167, v17 quad_perm:[2,2,2,2] row_mask:0xf bank_mask:0xa
    v_mov_b32_dpp v165, v21 quad_perm:[1,1,1,1] row_mask:0xf bank_mask:0xa
    v_mov_b32_dpp v166, v21 quad_perm:[1,1,1,1] row_mask:0xf bank_mask:0x5
    s_waitcnt vmcnt(4)
    v_smfmac_f32_16x16x64_bf16 v[24:27], v[160:163], v[96:103], v4
    v_mov_b32_dpp v160, v17 quad_perm:[3,3,3,3] row_mask:0xf bank_mask:0x5
    v_mov_b32_dpp v163, v17 quad_perm:[3,3,3,3] row_mask:0xf bank_mask:0xa
    v_mov_b32_dpp v161, v21 quad_perm:[0,0,0,0] row_mask:0xf bank_mask:0xa
    v_mov_b32_dpp v162, v21 quad_perm:[0,0,0,0] row_mask:0xf bank_mask:0x5
    s_waitcnt vmcnt(2)
    v_smfmac_f32_16x16x64_bf16 v[24:27], v[164:167], v[104:111], v4
    s_waitcnt vmcnt(0)
    v_smfmac_f32_16x16x64_bf16 v[24:27], v[160:163], v[112:119], v4
    s_nop 7
    v_permlane32_swap_b32 v24, v32
    v_permlane32_swap_b32 v25, v33
    v_permlane32_swap_b32 v26, v34
    v_permlane32_swap_b32 v27, v35
    v_add_f32_dpp v24, v32, v24 row_ror:8 row_mask:0xf bank_mask:0xf
    v_add_f32_dpp v25, v33, v25 row_ror:8 row_mask:0xf bank_mask:0xf
    v_add_f32_dpp v26, v34, v26 row_ror:8 row_mask:0xf bank_mask:0xf
    v_add_f32_dpp v27, v35, v27 row_ror:8 row_mask:0xf bank_mask:0xf
    v_add_u32 v24, s48, v24
    v_add_u32 v25, s49, v25
    v_add_u32 v26, s50, v26
    v_add_u32 v27, s51, v27
    v_bfi_b32 v24, v19, s14, v24
    v_bfi_b32 v25, v19, s28, v25
    v_bfi_b32 v26, v19, s29, v26
    v_bfi_b32 v27, v19, s15, v27
    s_mov_b64 exec, 0xff00ff
    global_store_dwordx4 v18, v[24:27], s[30:31] sc1
    s_cmp_ge_u32 s35, 14
    s_cbranch_scc1 L_Hr
    v_add_u32 v18, 0x4000, v18
    global_store_dwordx4 v18, v[24:27], s[30:31] sc1
    v_add_u32 v18, 0x4000, v18
    global_store_dwordx4 v18, v[24:27], s[30:31] sc1
    v_add_u32 v18, 0x4000, v18
    global_store_dwordx4 v18, v[24:27], s[30:31] sc1
    v_add_u32 v18, 0x4000, v18
    global_store_dwordx4 v18, v[24:27], s[30:31] sc1
    v_add_u32 v18, 0x4000, v18
    global_store_dwordx4 v18, v[24:27], s[30:31] sc1
    v_add_u32 v18, 0x4000, v18
    global_store_dwordx4 v18, v[24:27], s[30:31] sc1
    v_add_u32 v18, 0x4000, v18
    global_store_dwordx4 v18, v[24:27], s[30:31] sc1
    s_waitcnt vmcnt(0)
L_Hr:
    s_mov_b64 exec, -1
L_Hb1:
    s_barrier
L_Hb2:
    s_mul_i32 s97, s0, 7
    s_add_u32 s97, s97, s1
    s_lshr_b32 s36, s97, 2
    s_cmp_eq_u32 s36, 1
    s_cselect_b32 s36, 2, 0
    s_xor_b32 s97, s97, s36
    s_cmp_eq_u32 s1, 7
    s_cbranch_scc1 L_fin
    s_lshl_b32 s36, s0, 2
    s_lshr_b32 s36, 0x54321054, s36
    s_and_b32 s36, s36, 7
    s_sub_u32 s36, s1, s36
    s_bitcmp1_b32 s0, 0
    s_cselect_b32 s37, 0, 6
    s_cmp_eq_u32 s1, s37
    s_cselect_b32 s36, 0, s36
    s_cmp_lt_u32 s36, 2
    s_cbranch_scc1 L_EF
    s_barrier
    s_branch L_EF
L_B2:
    s_load_dword s14, s[30:31], 17408
    v_and_b32 v4, 3, v0
    v_mul_u32_u24 v4, 0x5555, v4
    v_mov_b64 v[160:161], 0
    v_mov_b64 v[162:163], 0
    v_mov_b64 v[164:165], 0
    v_mov_b64 v[166:167], 0
    v_mov_b64 v[24:25], 0
    v_mov_b64 v[26:27], 0
    s_lshl_b32 s36, s33, 8
    v_lshl_add_u32 v15, v3, 4, s36
    v_cmp_lt_u32 vcc, 895, v15
    s_nop 1
    v_cndmask_b32 v22, 0, 64, vcc
    v_lshl_add_u32 v15, v22, 1, v15
    s_lshl_b32 s36, s0, 14
    s_add_u32 s36, s36, 1704448
    v_lshl_add_u32 v15, v2, 12, v15
    v_add_u32 v15, s36, v15
    v_lshrrev_b32 v22, 1, v2
    s_lshl_b32 s32, s3, 1
    v_add_u32 v22, s32, v22
    v_mul_u32_u24 v21, 320, v22
    v_and_b32 v22, 7, v3
    v_lshl_add_u32 v21, v22, 5, v21
    v_and_b32 v22, 1, v2
    v_lshl_add_u32 v21, v22, 4, v21
    v_mov_b32 v31, 5120
    s_waitcnt lgkmcnt(0)
    s_add_u32 s14, s14, 0x01010101
    s_lshr_b32 s28, s14, 8
    s_lshr_b32 s29, s14, 16
    s_lshr_b32 s15, s14, 24
    s_mov_b32 s22, 0x0c0c0400
    s_mov_b32 s23, 0x04000c0c
    v_mov_b32 v19, 0xff
    v_lshl_add_u32 v9, v6, 4, v7
    v_mul_u32_u24 v9, 896, v9
    v_add_u32 v9, v9, v8
    s_lshl_b32 s38, s0, 3
    s_add_u32 s38, s38, s3
    s_mul_i32 s38, s38, 57344
    s_min_u32 s39, s1, 6
    s_lshl_b32 s39, s39, 7
    s_add_u32 s38, s38, s39
    s_add_u32 s12, s12, s38
    s_addc_u32 s13, s13, 0
    s_waitcnt vmcnt(0)
    s_barrier
    global_load_dwordx4 v[32:35], v15, s[30:31] sc1
    global_load_dwordx4 v[36:39], v15, s[30:31] offset:2048 sc1
    s_cmp_eq_u32 s1, 7
    s_cbranch_scc1 L_Bnw
    global_load_dwordx4 v[96:99], v9, s[12:13] nt
    s_add_u32 s12, s12, 1792
    s_addc_u32 s13, s13, 0
    global_load_dwordx4 v[100:103], v9, s[12:13] nt
    s_add_u32 s12, s12, 1792
    s_addc_u32 s13, s13, 0
L_Bnw:
    ds_read_b64 v[40:41], v31
    s_waitcnt vmcnt(10) lgkmcnt(0)
    v_lshlrev_b32 v20, 16, v20
    v_sub_f32 v20, v20, v40
    v_cvt_pk_bf16_f32 v20, v20, v20
    v_and_b32 v20, 0xffff0000, v20
    v_mul_f32 v20, v20, v41
    v_cvt_pk_bf16_f32 v20, v20, v20
    v_and_b32 v20, 0xffff0000, v20
    s_cmp_eq_u32 s1, 7
    s_cbranch_scc1 L_bg_1
    s_waitcnt vmcnt(2)
    s_branch L_Bt2
L_bg_1:
    s_waitcnt vmcnt(0)
L_Bt2:
    v_perm_b32 v40, v33, v32, s22
    v_perm_b32 v41, v35, v34, s23
    v_perm_b32 v42, v37, v36, s22
    v_perm_b32 v43, v39, v38, s23
    v_bitop3_b32 v40, v40, v41, s14 bitop3:0x56
    v_bitop3_b32 v42, v42, v43, s14 bitop3:0x56
    v_or_b32 v40, v40, v42
    v_cmp_ne_u32 vcc, 0, v40
    s_cbranch_vccz L_bo_2
    global_load_dwordx4 v[32:35], v15, s[30:31] sc1
    global_load_dwordx4 v[36:39], v15, s[30:31] offset:2048 sc1
    s_sub_i32 s96, s96, 1
    s_cmp_gt_i32 s96, 0
    s_cbranch_scc1 L_bg_1
    s_waitcnt vmcnt(0)
L_bo_2:
    v_permlane32_swap_b32 v36, v38
    v_permlane32_swap_b32 v37, v39
    v_permlane32_swap_b32 v32, v34
    v_permlane32_swap_b32 v33, v35
    v_add_f32 v36, v36, v38
    v_add_f32 v37, v37, v39
    v_add_f32 v32, v32, v34
    v_add_f32 v33, v33, v35
    v_permlane16_swap_b32 v36, v37
    s_nop 0
    v_permlane16_swap_b32 v32, v33
    v_add_f32 v36, v36, v37
    v_add_f32 v32, v32, v33
    v_cvt_pk_bf16_f32 v36, v32, v36
    v_lshlrev_b32 v32, 16, v36
    v_and_b32 v36, 0xffff0000, v36
    v_add_f32 v36, 1.0, v36
    v_cvt_pk_bf16_f32 v36, v36, v36
    v_and_b32 v36, 0xffff0000, v36
    v_mul_f32 v36, v20, v36
    v_cvt_pk_bf16_f32 v36, v36, v36
    v_and_b32 v36, 0xffff0000, v36
    v_add_f32 v36, v36, v32
    v_cvt_pk_bf16_f32 v36, v36, 0
    s_nop 1
    v_mov_b32_dpp v37, v36 row_half_mirror row_mask:0xf bank_mask:0xf
    v_mov_b32_dpp v160, v36 quad_perm:[0,0,0,0] row_mask:0xf bank_mask:0x5
    v_mov_b32_dpp v163, v36 quad_perm:[0,0,0,0] row_mask:0xf bank_mask:0xa
    v_mov_b32_dpp v161, v37 quad_perm:[3,3,3,3] row_mask:0xf bank_mask:0xa
    v_mov_b32_dpp v162, v37 quad_perm:[3,3,3,3] row_mask:0xf bank_mask:0x5
    v_mov_b32_dpp v164, v36 quad_perm:[1,1,1,1] row_mask:0xf bank_mask:0x5
    v_mov_b32_dpp v167, v36 quad_perm:[1,1,1,1] row_mask:0xf bank_mask:0xa
    v_mov_b32_dpp v165, v37 quad_perm:[2,2,2,2] row_mask:0xf bank_mask:0xa
    v_mov_b32_dpp v166, v37 quad_perm:[2,2,2,2] row_mask:0xf bank_mask:0x5
    v_smfmac_f32_16x16x64_bf16 v[24:27], v[160:163], v[64:71], v4
    v_mov_b32_dpp v160, v36 quad_perm:[2,2,2,2] row_mask:0xf bank_mask:0x5
    v_mov_b32_dpp v163, v36 quad_perm:[2,2,2,2] row_mask:0xf bank_mask:0xa
    v_mov_b32_dpp v161, v37 quad_perm:[1,1,1,1] row_mask:0xf bank_mask:0xa
    v_mov_b32_dpp v162, v37 quad_perm:[1,1,1,1] row_mask:0xf bank_mask:0x5
    v_smfmac_f32_16x16x64_bf16 v[24:27], v[164:167], v[72:79], v4
    v_mov_b32_dpp v164, v36 quad_perm:[3,3,3,3] row_mask:0xf bank_mask:0x5
    v_mov_b32_dpp v167, v36 quad_perm:[3,3,3,3] row_mask:0xf bank_mask:0xa
    v_mov_b32_dpp v165, v37 quad_perm:[0,0,0,0] row_mask:0xf bank_mask:0xa
    v_mov_b32_dpp v166, v37 quad_perm:[0,0,0,0] row_mask:0xf bank_mask:0x5
    v_smfmac_f32_16x16x64_bf16 v[24:27], v[160:163], v[80:87], v4
    s_nop 0
    v_smfmac_f32_16x16x64_bf16 v[24:27], v[164:167], v[88:95], v4
    s_mov_b32 exec_lo, 0xff00ff
    s_mov_b32 exec_hi, 0xff00ff00
    s_nop 5
    ds_write_b128 v21, v[24:27] offset:0
    s_mov_b64 exec, -1
    s_waitcnt lgkmcnt(0)
    s_barrier
L_Bdone:
    s_barrier
    s_cmp_lt_u32 s1, 7
    s_cbranch_scc1 L_D
    s_branch L_fin
L_B7:
    s_load_dword s14, s[30:31], 17408
    v_and_b32 v4, 3, v0
    v_mul_u32_u24 v4, 0x5555, v4
    v_mov_b64 v[160:161], 0
    v_mov_b64 v[162:163], 0
    v_mov_b64 v[164:165], 0
    v_mov_b64 v[166:167], 0
    v_mov_b64 v[24:25], 0
    v_mov_b64 v[26:27], 0
    v_lshrrev_b32 v22, 1, v2
    s_lshl_b32 s32, s3, 1
    v_add_u32 v22, s32, v22
    v_mul_u32_u24 v21, 320, v22
    v_and_b32 v22, 7, v3
    v_lshl_add_u32 v21, v22, 5, v21
    v_and_b32 v22, 1, v2
    v_lshl_add_u32 v21, v22, 4, v21
    v_and_b32 v22, 3, v1
    v_mul_u32_u24 v23, 320, v22
    v_lshrrev_b32 v22, 2, v1
    v_lshl_add_u32 v23, v22, 4, v23
    s_lshl_b32 s36, s97, 9
    s_add_u32 s36, s36, 1048576
    v_lshrrev_b32 v51, 2, v1
    v_lshl_add_u32 v50, v51, 4, s36
    s_lshl_b32 s36, s97, 13
    s_add_u32 s36, s36, 6295552
    v_lshl_add_u32 v52, v51, 4, s36
    v_and_b32 v51, 3, v1
    v_lshl_add_u32 v52, v51, 9, v52
    v_cmp_gt_u32 vcc, 56, v1
    s_nop 1
    v_cndmask_b32 v31, 0, 1.0, vcc
    v_mov_b32 v30, 5120
    s_mov_b32 exec_lo, 0xff00ff
    s_mov_b32 exec_hi, 0xff00ff00
    ds_write_b128 v21, v[24:27] offset:0
    s_mov_b64 exec, -1
    s_waitcnt vmcnt(0)
    v_lshlrev_b32 v32, 16, v16
    v_and_b32 v33, 0xffff0000, v16
    v_lshlrev_b32 v34, 16, v17
    v_and_b32 v35, 0xffff0000, v17
    v_lshlrev_b32 v36, 16, v18
    v_and_b32 v37, 0xffff0000, v18
    v_lshlrev_b32 v38, 16, v19
    v_and_b32 v39, 0xffff0000, v19
    v_pk_add_f32 v[40:41], v[32:33], v[34:35]
    v_pk_add_f32 v[42:43], v[36:37], v[38:39]
    v_pk_add_f32 v[40:41], v[40:41], v[42:43]
    v_add_f32 v40, v40, v41
    v_mul_f32 v40, v40, v31
    s_nop 1
    v_add_f32_dpp v40, v40, v40 quad_perm:[1,0,3,2] row_mask:0xf bank_mask:0xf
    s_nop 1
    v_add_f32_dpp v40, v40, v40 quad_perm:[2,3,0,1] row_mask:0xf bank_mask:0xf
    s_nop 1
    v_add_f32_dpp v40, v40, v40 row_half_mirror row_mask:0xf bank_mask:0xf
    s_nop 1
    v_add_f32_dpp v40, v40, v40 row_mirror row_mask:0xf bank_mask:0xf
    v_mov_b32 v41, v40
    s_nop 1
    v_permlane16_swap_b32 v40, v41
    v_add_f32 v40, v40, v41
    v_mov_b32 v41, v40
    s_nop 1
    v_permlane32_swap_b32 v40, v41
    v_add_f32 v40, v40, v41
    v_mul_f32 v40, 0x3b124925, v40
    v_sub_f32 v32, v32, v40
    v_sub_f32 v33, v33, v40
    v_sub_f32 v34, v34, v40
    v_sub_f32 v35, v35, v40
    v_sub_f32 v36, v36, v40
    v_sub_f32 v37, v37, v40
    v_sub_f32 v38, v38, v40
    v_sub_f32 v39, v39, v40
    v_mul_f32 v42, v32, v32
    v_fmac_f32 v42, v33, v33
    v_fmac_f32 v42, v34, v34
    v_fmac_f32 v42, v35, v35
    v_fmac_f32 v42, v36, v36
    v_fmac_f32 v42, v37, v37
    v_fmac_f32 v42, v38, v38
    v_fmac_f32 v42, v39, v39
    v_mul_f32 v42, v42, v31
    s_nop 1
    v_add_f32_dpp v42, v42, v42 quad_perm:[1,0,3,2] row_mask:0xf bank_mask:0xf
    s_nop 1
    v_add_f32_dpp v42, v42, v42 quad_perm:[2,3,0,1] row_mask:0xf bank_mask:0xf
    s_nop 1
    v_add_f32_dpp v42, v42, v42 row_half_mirror row_mask:0xf bank_mask:0xf
    s_nop 1
    v_add_f32_dpp v42, v42, v42 row_mirror row_mask:0xf bank_mask:0xf
    v_mov_b32 v41, v42
    s_nop 1
    v_permlane16_swap_b32 v42, v41
    v_add_f32 v42, v42, v41
    v_mov_b32 v41, v42
    s_nop 1
    v_permlane32_swap_b32 v42, v41
    v_add_f32 v42, v42, v41
    v_mul_f32 v42, 0x3b124925, v42
    v_cvt_pk_bf16_f32 v40, v40, v40
    v_and_b32 v40, 0xffff0000, v40
    v_cvt_pk_bf16_f32 v42, v42, v42
    v_and_b32 v42, 0xffff0000, v42
    v_add_f32 v42, 0x3727c5ac, v42
    v_cvt_pk_bf16_f32 v42, v42, v42
    v_and_b32 v42, 0xffff0000, v42
    v_sqrt_f32 v42, v42
    s_nop 0
    v_cvt_pk_bf16_f32 v42, v42, v42
    v_and_b32 v42, 0xffff0000, v42
    v_rcp_f32 v41, v42
    ds_write_b64 v30, v[40:41]
    s_waitcnt lgkmcnt(0)
    s_barrier
    s_add_u32 s14, s14, 0x01010101
    s_lshr_b32 s28, s14, 8
    s_lshr_b32 s29, s14, 16
    s_lshr_b32 s15, s14, 24
    s_mov_b32 s22, 0x0c0c0400
    s_mov_b32 s23, 0x04000c0c
    v_mov_b32 v19, 0xff
    v_mov_b32 v58, s14
    v_mov_b32 v59, s14
    s_barrier
    ds_read_b128 v[32:35], v23 offset:0
    ds_read_b128 v[36:39], v23 offset:1280
    ds_read_b128 v[40:43], v23 offset:2560
    ds_read_b128 v[44:47], v23 offset:3840
    s_waitcnt lgkmcnt(0)
    v_pk_add_f32 v[32:33], v[32:33], v[36:37]
    v_pk_add_f32 v[34:35], v[34:35], v[38:39]
    v_pk_add_f32 v[40:41], v[40:41], v[44:45]
    v_pk_add_f32 v[42:43], v[42:43], v[46:47]
    v_pk_add_f32 v[32:33], v[32:33], v[40:41]
    v_pk_add_f32 v[34:35], v[34:35], v[42:43]
    s_nop 0
    v_add_f32_dpp v32, v32, v32 quad_perm:[1,0,3,2] row_mask:0xf bank_mask:0xf
    v_add_f32_dpp v33, v33, v33 quad_perm:[1,0,3,2] row_mask:0xf bank_mask:0xf
    v_add_f32_dpp v34, v34, v34 quad_perm:[1,0,3,2] row_mask:0xf bank_mask:0xf
    v_add_f32_dpp v35, v35, v35 quad_perm:[1,0,3,2] row_mask:0xf bank_mask:0xf
    v_add_f32_dpp v32, v32, v32 quad_perm:[2,3,0,1] row_mask:0xf bank_mask:0xf
    v_add_f32_dpp v33, v33, v33 quad_perm:[2,3,0,1] row_mask:0xf bank_mask:0xf
    v_add_f32_dpp v34, v34, v34 quad_perm:[2,3,0,1] row_mask:0xf bank_mask:0xf
    v_add_f32_dpp v35, v35, v35 quad_perm:[2,3,0,1] row_mask:0xf bank_mask:0xf
    v_cvt_pk_bf16_f32 v56, v32, v33
    v_cvt_pk_bf16_f32 v57, v34, v35
    global_store_dwordx4 v52, v[56:59], s[30:31] offset:-4096
    global_store_dwordx4 v52, v[56:59], s[30:31] offset:-2048
    global_store_dwordx4 v52, v[56:59], s[30:31] offset:0
    global_store_dwordx4 v52, v[56:59], s[30:31] offset:2048
    s_mov_b32 exec_lo, 0x11111111
    s_mov_b32 exec_hi, 0x11111111
    global_store_dwordx4 v50, v[56:59], s[30:31] sc1
    s_mov_b64 exec, -1
    s_cmp_eq_u32 s1, 7
    s_cbranch_scc1 L_fin
    s_barrier
    v_lshl_add_u32 v9, v6, 4, v7
    v_mul_u32_u24 v9, 896, v9
    v_add_u32 v9, v9, v8
    s_lshl_b32 s38, s0, 3
    s_add_u32 s38, s38, s3
    s_mul_i32 s38, s38, 57344
    s_min_u32 s39, s1, 6
    s_lshl_b32 s39, s39, 7
    s_add_u32 s38, s38, s39
    s_add_u32 s12, s12, s38
    s_addc_u32 s13, s13, 0
    global_load_dwordx4 v[96:99], v9, s[12:13] nt
    s_add_u32 s12, s12, 1792
    s_addc_u32 s13, s13, 0
    global_load_dwordx4 v[100:103], v9, s[12:13] nt
    s_add_u32 s12, s12, 1792
    s_addc_u32 s13, s13, 0
    s_branch L_D
L_X2:
    v_lshlrev_b32 v9, 9, v2
    v_lshl_add_u32 v9, v3, 4, v9
    s_lshl4_add_u32 s97, s0, s34
    s_lshl_b32 s36, s0, 16
    s_lshl_b32 s37, s3, 15
    s_add_u32 s36, s36, s37
    s_lshl_b32 s37, s34, 11
    s_add_u32 s36, s36, s37
    s_add_u32 s36, s36, 393728
    v_lshl_add_u32 v39, v1, 4, s36
    v_and_b32 v40, 32, v1
    v_lshl_add_u32 v39, v40, 4, v39
    s_lshl_b32 s36, s0, 10
    s_lshl4_add_u32 s36, s34, s36
    s_add_u32 s36, s36, 98816
    v_lshl_add_u32 v15, v1, 5, s36
    s_add_u32 s10, s30, 4194304
    s_addc_u32 s11, s31, 0
    s_sub_u32 s36, s3, 2
    s_cmp_lt_u32 s36, 5
    s_cbranch_scc1 L_Xnd
    s_cmp_eq_u32 s3, 7
    s_cselect_b64 vcc, -1, 0
    v_cndmask_b32 v12, v39, v15, vcc
    s_cselect_b64 exec, 0x101, -1
    s_waitcnt lgkmcnt(0)
    v_mov_b32 v40, s14
    v_mov_b32 v41, s14
    v_mov_b32 v42, s14
    v_mov_b32 v43, s14
    global_store_dwordx4 v12, v[40:43], s[10:11]
    s_mov_b64 exec, -1
L_Xnd:
    s_barrier
    global_load_dwordx4 v[64:67], v9, s[42:43] offset:0 nt
    global_load_dwordx4 v[72:75], v9, s[42:43] offset:256 nt
    global_load_dwordx4 v[68:71], v9, s[42:43] offset:2048 nt
    v_and_b32 v4, 3, v0
    v_mul_u32_u24 v4, 0x5555, v4
    v_mov_b64 v[160:161], 0
    v_mov_b64 v[162:163], 0
    v_mov_b64 v[164:165], 0
    v_mov_b64 v[166:167], 0
    v_mov_b64 v[24:25], 0
    v_mov_b64 v[26:27], 0
    v_mov_b64 v[28:29], 0
    v_mov_b64 v[30:31], 0
    v_mov_b64 v[12:13], 0
    s_mul_i32 s36, s0, 7
    s_and_b32 s37, s3, 6
    s_add_u32 s36, s36, s37
    s_lshr_b32 s37, s36, 2
    s_cmp_eq_u32 s37, 1
    s_cselect_b32 s37, 2, 0
    s_xor_b32 s36, s36, s37
    s_lshr_b32 s36, s36, 1
    s_lshl_b32 s36, s36, 7
    s_bitcmp1_b32 s3, 0
    s_cselect_b32 s6, s18, s16
    s_cselect_b32 s7, s19, s17
    s_mul_i32 s37, s34, 12
    s_add_u32 s37, s37, 256
    v_mul_u32_u24 v62, 12, v1
    v_lshrrev_b32 v62, 6, v62
    v_add_u32 v62, s37, v62
    v_min_u32 v62, 447, v62
    v_mul_u32_u24 v62, 3584, v62
    v_add_u32 v62, s36, v62
    s_and_b32 s36, s3, 3
    s_lshl_b32 s37, s36, 3
    v_xor_b32 v16, s37, v3
    v_lshlrev_b32 v16, 4, v16
    v_lshl_add_u32 v16, v1, 9, v16
    v_xor_b32 v17, 16, v16
    v_xor_b32 v18, 32, v16
    v_xor_b32 v19, 48, v16
    v_xor_b32 v20, 64, v16
    v_xor_b32 v21, 80, v16
    v_xor_b32 v22, 96, v16
    v_xor_b32 v23, 112, v16
    s_lshr_b32 s37, s3, 2
    s_mul_i32 s37, s37, 2176
    s_lshl_b32 s36, s36, 2
    s_add_u32 s36, s36, s37
    s_add_u32 s36, s36, 65536
    v_lshl_add_u32 v36, v1, 4, s36
    v_lshrrev_b32 v40, 3, v3
    v_mul_u32_u24 v40, 2176, v40
    v_add_u32 v40, 65536, v40
    v_lshl_add_u32 v40, v2, 5, v40
    v_bfe_u32 v41, v3, 2, 1
    v_lshl_add_u32 v40, v41, 4, v40
    v_and_b32 v41, 1, v3
    v_mul_u32_u24 v41, 1088, v41
    v_add_u32 v40, v40, v41
    v_bfe_u32 v41, v3, 1, 1
    v_add_u32 v41, s3, v41
    v_add_u32 v42, 0, v41
    v_and_b32 v42, 7, v42
    v_lshl_add_u32 v32, v42, 7, v40
    v_add_u32 v42, 2, v41
    v_and_b32 v42, 7, v42
    v_lshl_add_u32 v33, v42, 7, v40
    v_add_u32 v42, 4, v41
    v_and_b32 v42, 7, v42
    v_lshl_add_u32 v34, v42, 7, v40
    v_add_u32 v42, 6, v41
    v_and_b32 v42, 7, v42
    v_lshl_add_u32 v35, v42, 7, v40
    v_lshrrev_b32 v40, 1, v2
    v_lshlrev_b32 v37, 10, v40
    v_lshl_add_u32 v37, v3, 5, v37
    v_and_b32 v40, 1, v2
    v_lshl_add_u32 v37, v40, 4, v37
    s_lshl_b32 s36, s3, 11
    v_add_u32 v37, s36, v37
    s_lshl_b32 s36, s3, 10
    v_lshl_add_u32 v38, v1, 4, s36
    s_lshl3_add_u32 s36, s0, s3
    s_lshl_b32 s37, s36, 9
    s_add_u32 s37, s37, 1048576
    s_add_u32 s16, s30, s37
    s_addc_u32 s17, s31, 0
    s_lshl_b32 s36, s36, 13
    s_add_u32 s36, s36, 6291456
    s_add_u32 s8, s30, s36
    s_addc_u32 s9, s31, 0
    s_mov_b32 s1, s34
    s_waitcnt lgkmcnt(0)
    s_add_u32 s14, s14, 0x01010101
    s_lshr_b32 s28, s14, 8
    s_lshr_b32 s29, s14, 16
    s_lshr_b32 s15, s14, 24
    s_mov_b32 s22, 0x0c0c0400
    s_mov_b32 s23, 0x04000c0c
    v_mov_b32 v14, 0xff
    s_lshl_b32 s18, s14, 4
    s_waitcnt vmcnt(3)
    s_barrier
    ds_read_b128 v[96:99], v16 offset:0
    ds_read_b128 v[100:103], v17 offset:0
    ds_read_b128 v[104:107], v18 offset:0
    ds_read_b128 v[108:111], v19 offset:0
    ds_read_b128 v[112:115], v20 offset:0
    ds_read_b128 v[116:119], v21 offset:0
    ds_read_b128 v[120:123], v22 offset:0
    ds_read_b128 v[124:127], v23 offset:0
    ds_read_b128 v[128:131], v16 offset:32768
    ds_read_b128 v[132:135], v17 offset:32768
    ds_read_b128 v[136:139], v18 offset:32768
    ds_read_b128 v[140:143], v19 offset:32768
    ds_read_b128 v[144:147], v20 offset:32768
    ds_read_b128 v[148:151], v21 offset:32768
    ds_read_b128 v[152:155], v22 offset:32768
    ds_read_b128 v[156:159], v23 offset:32768
    global_load_dwordx4 v[76:79], v9, s[42:43] offset:2304 nt
    s_add_u32 s42, s42, 32768
    s_addc_u32 s43, s43, 0
    global_load_dwordx4 v[80:83], v9, s[42:43] offset:0 nt
    global_load_dwordx4 v[88:91], v9, s[42:43] offset:256 nt
    global_load_dwordx4 v[84:87], v9, s[42:43] offset:2048 nt
    global_load_dwordx4 v[92:95], v9, s[42:43] offset:2304 nt
L_qc_5:
    s_load_dwordx16 s[32:47], s[8:9], 0
    s_load_dwordx16 s[48:63], s[8:9], 64
    s_load_dwordx16 s[64:79], s[8:9], 128
    s_load_dwordx16 s[80:95], s[8:9], 192
    s_waitcnt lgkmcnt(0)
    s_add_u32 s20, s34, s38
    s_add_u32 s20, s20, s42
    s_add_u32 s20, s20, s46
    s_add_u32 s20, s20, s50
    s_add_u32 s20, s20, s54
    s_add_u32 s20, s20, s58
    s_add_u32 s20, s20, s62
    s_add_u32 s20, s20, s66
    s_add_u32 s20, s20, s70
    s_add_u32 s20, s20, s74
    s_add_u32 s20, s20, s78
    s_add_u32 s20, s20, s82
    s_add_u32 s20, s20, s86
    s_add_u32 s20, s20, s90
    s_add_u32 s20, s20, s94
    s_cmp_eq_u32 s20, s18
    s_cbranch_scc1 L_qo_4
    s_add_u32 s8, s8, 512
    s_addc_u32 s9, s9, 0
    s_sub_u32 s96, s96, 1
    s_cmpk_gt_u32 s96, 32751
    s_cbranch_scc1 L_qc_5
L_qg_3:
    s_load_dwordx16 s[32:47], s[16:17], 0 glc
    s_load_dwordx16 s[48:63], s[16:17], 64 glc
    s_load_dwordx16 s[64:79], s[16:17], 128 glc
    s_load_dwordx16 s[80:95], s[16:17], 192 glc
    s_waitcnt lgkmcnt(0)
    s_add_u32 s20, s34, s38
    s_add_u32 s20, s20, s42
    s_add_u32 s20, s20, s46
    s_add_u32 s20, s20, s50
    s_add_u32 s20, s20, s54
    s_add_u32 s20, s20, s58
    s_add_u32 s20, s20, s62
    s_add_u32 s20, s20, s66
    s_add_u32 s20, s20, s70
    s_add_u32 s20, s20, s74
    s_add_u32 s20, s20, s78
    s_add_u32 s20, s20, s82
    s_add_u32 s20, s20, s86
    s_add_u32 s20, s20, s90
    s_add_u32 s20, s20, s94
    s_cmp_eq_u32 s20, s18
    s_cbranch_scc1 L_qo_4
    s_sub_i32 s96, s96, 1
    s_cmp_gt_i32 s96, 0
    s_cbranch_scc1 L_qg_3
L_qo_4:
    v_dot2c_f32_bf16 v12, s32, v96
    v_dot2c_f32_bf16 v13, s32, v128
    v_dot2c_f32_bf16 v12, s33, v97
    v_dot2c_f32_bf16 v13, s33, v129
    v_dot2c_f32_bf16 v12, s36, v98
    v_dot2c_f32_bf16 v13, s36, v130
    v_dot2c_f32_bf16 v12, s37, v99
    v_dot2c_f32_bf16 v13, s37, v131
    v_dot2c_f32_bf16 v12, s40, v100
    v_dot2c_f32_bf16 v13, s40, v132
    v_dot2c_f32_bf16 v12, s41, v101
    v_dot2c_f32_bf16 v13, s41, v133
    v_dot2c_f32_bf16 v12, s44, v102
    v_dot2c_f32_bf16 v13, s44, v134
    v_dot2c_f32_bf16 v12, s45, v103
    v_dot2c_f32_bf16 v13, s45, v135
    v_dot2c_f32_bf16 v12, s48, v104
    v_dot2c_f32_bf16 v13, s48, v136
    v_dot2c_f32_bf16 v12, s49, v105
    v_dot2c_f32_bf16 v13, s49, v137
    v_dot2c_f32_bf16 v12, s52, v106
    v_dot2c_f32_bf16 v13, s52, v138
    v_dot2c_f32_bf16 v12, s53, v107
    v_dot2c_f32_bf16 v13, s53, v139
    v_dot2c_f32_bf16 v12, s56, v108
    v_dot2c_f32_bf16 v13, s56, v140
    v_dot2c_f32_bf16 v12, s57, v109
    v_dot2c_f32_bf16 v13, s57, v141
    v_dot2c_f32_bf16 v12, s60, v110
    v_dot2c_f32_bf16 v13, s60, v142
    v_dot2c_f32_bf16 v12, s61, v111
    v_dot2c_f32_bf16 v13, s61, v143
    v_dot2c_f32_bf16 v12, s64, v112
    v_dot2c_f32_bf16 v13, s64, v144
    v_dot2c_f32_bf16 v12, s65, v113
    v_dot2c_f32_bf16 v13, s65, v145
    v_dot2c_f32_bf16 v12, s68, v114
    v_dot2c_f32_bf16 v13, s68, v146
    v_dot2c_f32_bf16 v12, s69, v115
    v_dot2c_f32_bf16 v13, s69, v147
    v_dot2c_f32_bf16 v12, s72, v116
    v_dot2c_f32_bf16 v13, s72, v148
    v_dot2c_f32_bf16 v12, s73, v117
    v_dot2c_f32_bf16 v13, s73, v149
    v_dot2c_f32_bf16 v12, s76, v118
    v_dot2c_f32_bf16 v13, s76, v150
    v_dot2c_f32_bf16 v12, s77, v119
    v_dot2c_f32_bf16 v13, s77, v151
    v_dot2c_f32_bf16 v12, s80, v120
    v_dot2c_f32_bf16 v13, s80, v152
    v_dot2c_f32_bf16 v12, s81, v121
    v_dot2c_f32_bf16 v13, s81, v153
    v_dot2c_f32_bf16 v12, s84, v122
    v_dot2c_f32_bf16 v13, s84, v154
    v_dot2c_f32_bf16 v12, s85, v123
    v_dot2c_f32_bf16 v13, s85, v155
    v_dot2c_f32_bf16 v12, s88, v124
    v_dot2c_f32_bf16 v13, s88, v156
    v_dot2c_f32_bf16 v12, s89, v125
    v_dot2c_f32_bf16 v13, s89, v157
    v_dot2c_f32_bf16 v12, s92, v126
    v_dot2c_f32_bf16 v13, s92, v158
    v_dot2c_f32_bf16 v12, s93, v127
    v_dot2c_f32_bf16 v13, s93, v159
    s_nop 1
    ds_write_b32 v36, v12
    ds_write_b32 v36, v13 offset:1088
    s_waitcnt lgkmcnt(0)
    s_barrier
    ds_read_b128 v[40:43], v32
    ds_read_b128 v[44:47], v33
    ds_read_b128 v[48:51], v34
    ds_read_b128 v[52:55], v35
    s_waitcnt lgkmcnt(3)
    v_add_f32 v40, v40, v41
    v_add_f32 v42, v42, v43
    s_waitcnt lgkmcnt(2)
    v_add_f32 v44, v44, v45
    v_add_f32 v46, v46, v47
    v_add_f32 v40, v40, v42
    s_waitcnt lgkmcnt(1)
    v_add_f32 v48, v48, v49
    v_add_f32 v50, v50, v51
    v_add_f32 v44, v44, v46
    s_waitcnt lgkmcnt(0)
    v_add_f32 v52, v52, v53
    v_add_f32 v54, v54, v55
    v_add_f32 v48, v48, v50
    v_max3_f32 v56, v40, v44, v48
    v_add_f32 v52, v52, v54
    v_max_f32 v56, v56, v52
    s_nop 1
    v_max_f32_dpp v56, v56, v56 quad_perm:[1,0,3,2] row_mask:0xf bank_mask:0xf
    s_nop 1
    v_max_f32_dpp v56, v56, v56 quad_perm:[2,3,0,1] row_mask:0xf bank_mask:0xf
    s_nop 1
    v_max_f32_dpp v56, v56, v56 row_half_mirror row_mask:0xf bank_mask:0xf
    v_mov_b32 v57, v56
    s_nop 1
    v_permlane16_swap_b32 v56, v57
    v_max_f32 v56, v56, v57
    v_mov_b32 v57, v56
    s_nop 1
    v_permlane32_swap_b32 v56, v57
    v_max_f32 v56, v56, v57
    v_cvt_pk_bf16_f32 v57, v40, v56
    v_lshlrev_b32 v40, 16, v57
    v_and_b32 v56, 0xffff0000, v57
    v_sub_f32 v40, v40, v56
    v_mul_f32 v40, 0x3db8aa3b, v40
    v_exp_f32 v40, v40
    s_cmp_eq_u32 s3, 7
    s_cbranch_scc1 L_Xst
L_Xpv:
    v_cvt_pk_bf16_f32 v40, v40, 0
    s_nop 1
    v_mov_b32_dpp v41, v40 row_half_mirror row_mask:0xf bank_mask:0xf
    v_mov_b32_dpp v160, v40 quad_perm:[0,0,0,0] row_mask:0xf bank_mask:0x5
    v_mov_b32_dpp v163, v40 quad_perm:[0,0,0,0] row_mask:0xf bank_mask:0xa
    v_mov_b32_dpp v161, v41 quad_perm:[3,3,3,3] row_mask:0xf bank_mask:0xa
    v_mov_b32_dpp v162, v41 quad_perm:[3,3,3,3] row_mask:0xf bank_mask:0x5
    v_mov_b32_dpp v164, v40 quad_perm:[1,1,1,1] row_mask:0xf bank_mask:0x5
    v_mov_b32_dpp v167, v40 quad_perm:[1,1,1,1] row_mask:0xf bank_mask:0xa
    v_mov_b32_dpp v165, v41 quad_perm:[2,2,2,2] row_mask:0xf bank_mask:0xa
    v_mov_b32_dpp v166, v41 quad_perm:[2,2,2,2] row_mask:0xf bank_mask:0x5
    s_waitcnt vmcnt(4)
    v_smfmac_f32_16x16x64_bf16 v[24:27], v[160:163], v[64:71], v4
    v_smfmac_f32_16x16x64_bf16 v[28:31], v[160:163], v[72:79], v4
    s_waitcnt vmcnt(0)
    v_smfmac_f32_16x16x64_bf16 v[24:27], v[164:167], v[80:87], v4
    v_smfmac_f32_16x16x64_bf16 v[28:31], v[164:167], v[88:95], v4
    s_nop 6
    ds_write_b128 v37, v[24:27]
    ds_write_b128 v37, v[28:31] offset:512
    s_waitcnt lgkmcnt(0)
    s_barrier
    s_cmp_ge_u32 s3, 2
    s_cbranch_scc1 L_Xg
    ds_read_b128 v[64:67], v38 offset:0
    ds_read_b128 v[68:71], v38 offset:2048
    ds_read_b128 v[72:75], v38 offset:4096
    ds_read_b128 v[76:79], v38 offset:6144
    ds_read_b128 v[80:83], v38 offset:8192
    ds_read_b128 v[84:87], v38 offset:10240
    ds_read_b128 v[88:91], v38 offset:12288
    ds_read_b128 v[92:95], v38 offset:14336
    s_waitcnt lgkmcnt(6)
    v_pk_add_f32 v[64:65], v[64:65], v[68:69]
    v_pk_add_f32 v[66:67], v[66:67], v[70:71]
    s_waitcnt lgkmcnt(4)
    v_pk_add_f32 v[72:73], v[72:73], v[76:77]
    v_pk_add_f32 v[74:75], v[74:75], v[78:79]
    s_waitcnt lgkmcnt(2)
    v_pk_add_f32 v[80:81], v[80:81], v[84:85]
    v_pk_add_f32 v[82:83], v[82:83], v[86:87]
    s_waitcnt lgkmcnt(0)
    v_pk_add_f32 v[88:89], v[88:89], v[92:93]
    v_pk_add_f32 v[90:91], v[90:91], v[94:95]
    v_pk_add_f32 v[64:65], v[64:65], v[72:73]
    v_pk_add_f32 v[66:67], v[66:67], v[74:75]
    v_pk_add_f32 v[80:81], v[80:81], v[88:89]
    v_pk_add_f32 v[82:83], v[82:83], v[90:91]
    v_pk_add_f32 v[64:65], v[64:65], v[80:81]
    v_pk_add_f32 v[66:67], v[66:67], v[82:83]
    v_bfi_b32 v64, v14, s14, v64
    v_bfi_b32 v65, v14, s28, v65
    v_bfi_b32 v66, v14, s29, v66
    v_bfi_b32 v67, v14, s15, v67
    global_store_dwordx4 v39, v[64:67], s[10:11]
    global_store_dwordx4 v39, v[64:67], s[30:31] sc1
L_Xg:
    s_barrier
    global_load_dword v63, v62, s[6:7] nt
    s_lshl_b32 s1, s1, 3
    s_add_u32 s1, s1, s0
    s_cmp_eq_u32 s3, 3
    s_cselect_b32 s1, s1, 99
    s_cmp_lt_u32 s1, 28
    s_cbranch_scc1 L_G
L_fin:
    s_endpgm
L_Xst:
    v_cvt_pk_bf16_f32 v44, v44, v48
    v_cvt_pk_bf16_f32 v52, v52, v52
    v_and_b32 v48, 0xffff0000, v44
    v_lshlrev_b32 v44, 16, v44
    v_and_b32 v52, 0xffff0000, v52
    v_sub_f32 v44, v44, v56
    v_sub_f32 v48, v48, v56
    v_sub_f32 v52, v52, v56
    v_mul_f32 v44, 0x3db8aa3b, v44
    v_mul_f32 v48, 0x3db8aa3b, v48
    v_mul_f32 v52, 0x3db8aa3b, v52
    v_exp_f32 v44, v44
    v_exp_f32 v48, v48
    v_exp_f32 v52, v52
    v_add_f32 v57, v40, v44
    v_add_f32 v48, v48, v52
    v_mov_b32 v58, s14
    v_add_f32 v57, v57, v48
    s_nop 1
    v_add_f32_dpp v57, v57, v57 quad_perm:[1,0,3,2] row_mask:0xf bank_mask:0xf
    s_nop 1
    v_add_f32_dpp v57, v57, v57 quad_perm:[2,3,0,1] row_mask:0xf bank_mask:0xf
    s_nop 1
    v_add_f32_dpp v57, v57, v57 row_half_mirror row_mask:0xf bank_mask:0xf
    v_mov_b32 v59, v57
    s_nop 1
    v_permlane16_swap_b32 v57, v59
    v_add_f32 v57, v57, v59
    v_mov_b32 v59, v57
    s_nop 1
    v_permlane32_swap_b32 v57, v59
    v_add_f32 v57, v57, v59
    s_mov_b64 exec, 0x101
    global_store_dwordx4 v15, v[56:59], s[10:11]
    global_store_dwordx4 v15, v[56:59], s[30:31] sc1
    s_mov_b64 exec, -1
    v_cvt_pk_bf16_f32 v40, v40, 0
    s_nop 1
    v_mov_b32_dpp v41, v40 row_half_mirror row_mask:0xf bank_mask:0xf
    v_mov_b32_dpp v160, v40 quad_perm:[0,0,0,0] row_mask:0xf bank_mask:0x5
    v_mov_b32_dpp v163, v40 quad_perm:[0,0,0,0] row_mask:0xf bank_mask:0xa
    v_mov_b32_dpp v161, v41 quad_perm:[3,3,3,3] row_mask:0xf bank_mask:0xa
    v_mov_b32_dpp v162, v41 quad_perm:[3,3,3,3] row_mask:0xf bank_mask:0x5
    v_mov_b32_dpp v164, v40 quad_perm:[1,1,1,1] row_mask:0xf bank_mask:0x5
    v_mov_b32_dpp v167, v40 quad_perm:[1,1,1,1] row_mask:0xf bank_mask:0xa
    v_mov_b32_dpp v165, v41 quad_perm:[2,2,2,2] row_mask:0xf bank_mask:0xa
    v_mov_b32_dpp v166, v41 quad_perm:[2,2,2,2] row_mask:0xf bank_mask:0x5
    s_waitcnt vmcnt(6)
    v_smfmac_f32_16x16x64_bf16 v[24:27], v[160:163], v[64:71], v4
    v_smfmac_f32_16x16x64_bf16 v[28:31], v[160:163], v[72:79], v4
    s_waitcnt vmcnt(2)
    v_smfmac_f32_16x16x64_bf16 v[24:27], v[164:167], v[80:87], v4
    v_smfmac_f32_16x16x64_bf16 v[28:31], v[164:167], v[88:95], v4
    s_nop 6
    ds_write_b128 v37, v[24:27]
    ds_write_b128 v37, v[28:31] offset:512
    s_waitcnt lgkmcnt(0)
    s_barrier
    s_branch L_Xg
L_D:
    global_load_dwordx4 v[104:107], v9, s[12:13] nt
    s_add_u32 s12, s12, 1792
    s_addc_u32 s13, s13, 0
    global_load_dwordx4 v[108:111], v9, s[12:13] nt
    s_add_u32 s12, s12, 1792
    s_addc_u32 s13, s13, 0
    global_load_dwordx4 v[112:115], v9, s[12:13] nt
    s_add_u32 s12, s12, 1792
    s_addc_u32 s13, s13, 0
    global_load_dwordx4 v[116:119], v9, s[12:13] nt
    s_add_u32 s12, s12, 1792
    s_addc_u32 s13, s13, 0
    global_load_dwordx4 v[120:123], v9, s[12:13] nt
    s_add_u32 s12, s12, 1792
    s_addc_u32 s13, s13, 0
    global_load_dwordx4 v[124:127], v9, s[12:13] nt
    v_mov_b64 v[24:25], 0
    v_mov_b64 v[26:27], 0
    v_lshl_add_u32 v30, v2, 2, v3
    v_and_b32 v30, 15, v30
    s_lshr_b32 s34, s3, 2
    s_lshl2_add_u32 s35, s0, s34
    s_lshl_b32 s35, s35, 8
    s_add_u32 s35, s35, 98816
    v_lshl_add_u32 v30, v30, 4, s35
    v_lshlrev_b32 v31, 13, v2
    v_lshl_add_u32 v31, v3, 4, v31
    s_lshl_b32 s35, s0, 16
    s_lshl_b32 s34, s34, 15
    s_add_u32 s35, s35, s34
    s_and_b32 s34, s3, 1
    s_lshl_b32 s34, s34, 8
    s_add_u32 s35, s35, s34
    s_and_b32 s34, s3, 2
    s_lshl_b32 s34, s34, 9
    s_add_u32 s35, s35, s34
    s_add_u32 s35, s35, 397824
    v_add_u32 v31, s35, v31
    s_add_u32 s10, s30, 4194304
    s_addc_u32 s11, s31, 0
    s_mov_b64 s[42:43], s[10:11]
    s_barrier
    s_waitcnt vmcnt(0)
    global_load_dwordx3 v[32:34], v30, s[42:43] sc1
    global_load_dwordx4 v[40:43], v31, s[42:43] offset:-4096 sc1
    global_load_dwordx4 v[44:47], v31, s[42:43] offset:-2048 sc1
    global_load_dwordx4 v[48:51], v31, s[42:43] offset:0 sc1
    global_load_dwordx4 v[52:55], v31, s[42:43] offset:2048 sc1
    s_lshl_b32 s35, s1, 8
    v_lshl_add_u32 v20, v1, 2, s35
    v_cmp_lt_u32 vcc, 895, v20
    s_nop 1
    v_cndmask_b32 v10, 0, 64, vcc
    s_lshl_b32 s34, s0, 11
    s_add_u32 s34, s34, 1311232
    v_lshl_add_u32 v20, v10, 1, v20
    v_add_u32 v20, s34, v20
    v_and_b32 v10, 3, v1
    v_mul_u32_u24 v10, 16380, v10
    v_add_u32 v20, v20, v10
    v_add_u32 v18, 65536, v20
    v_lshrrev_b32 v22, 1, v2
    s_lshl_b32 s32, s3, 1
    v_add_u32 v22, s32, v22
    v_mul_u32_u24 v21, 320, v22
    v_and_b32 v22, 7, v3
    v_lshl_add_u32 v21, v22, 5, v21
    v_and_b32 v22, 1, v2
    v_lshl_add_u32 v21, v22, 4, v21
    v_and_b32 v22, 3, v1
    v_mul_u32_u24 v23, 320, v22
    v_lshrrev_b32 v22, 2, v1
    v_lshl_add_u32 v23, v22, 4, v23
    s_waitcnt vmcnt(4)
    v_cmp_ne_u32 vcc, s14, v34
    s_cbranch_vccz L_sgo_7
L_sg_6:
    s_cmpk_lt_u32 s96, 32703
    s_cselect_b32 s42, s30, s10
    s_cselect_b32 s43, s31, s11
    s_mov_b64 exec, vcc
    global_load_dwordx3 v[32:34], v30, s[42:43] sc1
    s_mov_b64 exec, -1
    s_waitcnt vmcnt(0)
    v_cmp_ne_u32 vcc, s14, v34
    s_cbranch_vccz L_sgo_7
    s_sub_i32 s96, s96, 1
    s_cmp_gt_i32 s96, 0
    s_cbranch_scc1 L_sg_6
L_sgo_7:
    global_load_dwordx4 v[40:43], v31, s[42:43] offset:-4096 sc1
    global_load_dwordx4 v[44:47], v31, s[42:43] offset:-2048 sc1
    global_load_dwordx4 v[48:51], v31, s[42:43] offset:0 sc1
    global_load_dwordx4 v[52:55], v31, s[42:43] offset:2048 sc1
    v_mov_b32 v35, v32
    s_nop 1
    v_max_f32_dpp v35, v35, v35 quad_perm:[1,0,3,2] row_mask:0xf bank_mask:0xf
    s_nop 1
    v_max_f32_dpp v35, v35, v35 quad_perm:[2,3,0,1] row_mask:0xf bank_mask:0xf
    s_nop 1
    v_max_f32_dpp v35, v35, v35 row_half_mirror row_mask:0xf bank_mask:0xf
    s_nop 1
    v_max_f32_dpp v35, v35, v35 row_mirror row_mask:0xf bank_mask:0xf
    v_sub_f32 v32, v32, v35
    v_mul_f32 v32, 0x3db8aa3b, v32
    v_exp_f32 v32, v32
    s_nop 0
    v_mul_f32 v33, v33, v32
    s_nop 1
    v_add_f32_dpp v33, v33, v33 quad_perm:[1,0,3,2] row_mask:0xf bank_mask:0xf
    s_nop 1
    v_add_f32_dpp v33, v33, v33 quad_perm:[2,3,0,1] row_mask:0xf bank_mask:0xf
    s_nop 1
    v_add_f32_dpp v33, v33, v33 row_half_mirror row_mask:0xf bank_mask:0xf
    s_nop 1
    v_add_f32_dpp v33, v33, v33 row_mirror row_mask:0xf bank_mask:0xf
    v_rcp_f32 v33, v33
    s_nop 0
    v_mul_f32 v32, v32, v33
    s_nop 1
    v_mov_b32_dpp v36, v32 row_newbcast:0 row_mask:0xf bank_mask:0xf
    v_mov_b32_dpp v37, v32 row_newbcast:1 row_mask:0xf bank_mask:0xf
    v_mov_b32_dpp v38, v32 row_newbcast:2 row_mask:0xf bank_mask:0xf
    v_mov_b32_dpp v39, v32 row_newbcast:3 row_mask:0xf bank_mask:0xf
L_og_8:
    s_waitcnt vmcnt(4)
    v_perm_b32 v56, v41, v40, s22
    v_perm_b32 v57, v43, v42, s23
    v_perm_b32 v58, v45, v44, s22
    v_perm_b32 v59, v47, v46, s23
    v_perm_b32 v60, v49, v48, s22
    v_perm_b32 v61, v51, v50, s23
    v_perm_b32 v62, v53, v52, s22
    v_perm_b32 v63, v55, v54, s23
    v_bitop3_b32 v56, v56, v57, s14 bitop3:0x56
    v_bitop3_b32 v58, v58, v59, s14 bitop3:0x56
    v_bitop3_b32 v60, v60, v61, s14 bitop3:0x56
    v_bitop3_b32 v62, v62, v63, s14 bitop3:0x56
    v_cmp_ne_u32 s[60:61], 0, v56
    v_cmp_ne_u32 s[62:63], 0, v58
    v_cmp_ne_u32 s[64:65], 0, v60
    v_cmp_ne_u32 s[66:67], 0, v62
    s_or_b64 s[68:69], s[60:61], s[62:63]
    s_or_b64 s[68:69], s[68:69], s[64:65]
    s_or_b64 s[68:69], s[68:69], s[66:67]
    s_cbranch_scc0 L_ogo_9
    s_cmpk_lt_u32 s96, 32703
    s_cselect_b32 s42, s30, s10
    s_cselect_b32 s43, s31, s11
    s_mov_b64 exec, s[60:61]
    global_load_dwordx4 v[40:43], v31, s[42:43] offset:-4096 sc1
    s_mov_b64 exec, s[62:63]
    global_load_dwordx4 v[44:47], v31, s[42:43] offset:-2048 sc1
    s_mov_b64 exec, s[64:65]
    global_load_dwordx4 v[48:51], v31, s[42:43] offset:0 sc1
    s_mov_b64 exec, s[66:67]
    global_load_dwordx4 v[52:55], v31, s[42:43] offset:2048 sc1
    s_mov_b64 exec, -1
    s_sub_i32 s96, s96, 1
    s_cmp_gt_i32 s96, 0
    s_cbranch_scc1 L_og_8
    s_waitcnt vmcnt(0)
L_ogo_9:
    v_pk_mul_f32 v[32:33], v[40:41], v[36:37] op_sel_hi:[1,0]
    v_pk_mul_f32 v[34:35], v[42:43], v[36:37] op_sel_hi:[1,0]
    v_pk_fma_f32 v[32:33], v[44:45], v[36:37], v[32:33] op_sel:[0,1,0] op_sel_hi:[1,1,1]
    v_pk_fma_f32 v[34:35], v[46:47], v[36:37], v[34:35] op_sel:[0,1,0] op_sel_hi:[1,1,1]
    v_pk_fma_f32 v[32:33], v[48:49], v[38:39], v[32:33] op_sel_hi:[1,0,1]
    v_pk_fma_f32 v[34:35], v[50:51], v[38:39], v[34:35] op_sel_hi:[1,0,1]
    v_pk_fma_f32 v[32:33], v[52:53], v[38:39], v[32:33] op_sel:[0,1,0] op_sel_hi:[1,1,1]
    v_pk_fma_f32 v[34:35], v[54:55], v[38:39], v[34:35] op_sel:[0,1,0] op_sel_hi:[1,1,1]
    s_nop 1
    v_permlane32_swap_b32 v32, v34
    v_permlane32_swap_b32 v33, v35
    v_add_f32 v32, v32, v34
    v_add_f32 v33, v33, v35
    s_nop 1
    v_permlane16_swap_b32 v32, v33
    v_add_f32 v32, v32, v33
    v_cvt_pk_bf16_f32 v32, v32, 0
    s_nop 1
    v_mov_b32_dpp v33, v32 row_half_mirror row_mask:0xf bank_mask:0xf
    v_mov_b32_dpp v160, v32 quad_perm:[0,0,0,0] row_mask:0xf bank_mask:0x5
    v_mov_b32_dpp v163, v32 quad_perm:[0,0,0,0] row_mask:0xf bank_mask:0xa
    v_mov_b32_dpp v161, v33 quad_perm:[3,3,3,3] row_mask:0xf bank_mask:0xa
    v_mov_b32_dpp v162, v33 quad_perm:[3,3,3,3] row_mask:0xf bank_mask:0x5
    v_mov_b32_dpp v164, v32 quad_perm:[1,1,1,1] row_mask:0xf bank_mask:0x5
    v_mov_b32_dpp v167, v32 quad_perm:[1,1,1,1] row_mask:0xf bank_mask:0xa
    v_mov_b32_dpp v165, v33 quad_perm:[2,2,2,2] row_mask:0xf bank_mask:0xa
    v_mov_b32_dpp v166, v33 quad_perm:[2,2,2,2] row_mask:0xf bank_mask:0x5
    v_smfmac_f32_16x16x64_bf16 v[24:27], v[160:163], v[96:103], v4
    v_mov_b32_dpp v160, v32 quad_perm:[2,2,2,2] row_mask:0xf bank_mask:0x5
    v_mov_b32_dpp v163, v32 quad_perm:[2,2,2,2] row_mask:0xf bank_mask:0xa
    v_mov_b32_dpp v161, v33 quad_perm:[1,1,1,1] row_mask:0xf bank_mask:0xa
    v_mov_b32_dpp v162, v33 quad_perm:[1,1,1,1] row_mask:0xf bank_mask:0x5
    v_smfmac_f32_16x16x64_bf16 v[24:27], v[164:167], v[104:111], v4
    v_mov_b32_dpp v164, v32 quad_perm:[3,3,3,3] row_mask:0xf bank_mask:0x5
    v_mov_b32_dpp v167, v32 quad_perm:[3,3,3,3] row_mask:0xf bank_mask:0xa
    v_mov_b32_dpp v165, v33 quad_perm:[0,0,0,0] row_mask:0xf bank_mask:0xa
    v_mov_b32_dpp v166, v33 quad_perm:[0,0,0,0] row_mask:0xf bank_mask:0x5
    v_smfmac_f32_16x16x64_bf16 v[24:27], v[160:163], v[112:119], v4
    s_nop 0
    v_smfmac_f32_16x16x64_bf16 v[24:27], v[164:167], v[120:127], v4
    s_mov_b32 exec_lo, 0xff00ff
    s_mov_b32 exec_hi, 0xff00ff00
    s_nop 5
    ds_write_b128 v21, v[24:27] offset:0
    s_mov_b64 exec, -1
    s_waitcnt lgkmcnt(0)
    s_barrier
    s_cmp_lg_u32 s3, 0
    s_cbranch_scc1 L_fin
    ds_read_b128 v[64:67], v23 offset:0
    ds_read_b128 v[68:71], v23 offset:1280
    ds_read_b128 v[72:75], v23 offset:2560
    ds_read_b128 v[76:79], v23 offset:3840
    s_waitcnt lgkmcnt(0)
    v_pk_add_f32 v[64:65], v[64:65], v[68:69]
    v_pk_add_f32 v[66:67], v[66:67], v[70:71]
    v_pk_add_f32 v[72:73], v[72:73], v[76:77]
    v_pk_add_f32 v[74:75], v[74:75], v[78:79]
    v_pk_add_f32 v[64:65], v[64:65], v[72:73]
    v_pk_add_f32 v[66:67], v[66:67], v[74:75]
    s_nop 0
    v_add_f32_dpp v64, v64, v64 quad_perm:[1,0,3,2] row_mask:0xf bank_mask:0xf
    v_add_f32_dpp v65, v65, v65 quad_perm:[1,0,3,2] row_mask:0xf bank_mask:0xf
    v_add_f32_dpp v66, v66, v66 quad_perm:[1,0,3,2] row_mask:0xf bank_mask:0xf
    v_add_f32_dpp v67, v67, v67 quad_perm:[1,0,3,2] row_mask:0xf bank_mask:0xf
    v_add_f32_dpp v64, v64, v64 quad_perm:[2,3,0,1] row_mask:0xf bank_mask:0xf
    v_add_f32_dpp v65, v65, v65 quad_perm:[2,3,0,1] row_mask:0xf bank_mask:0xf
    v_add_f32_dpp v66, v66, v66 quad_perm:[2,3,0,1] row_mask:0xf bank_mask:0xf
    v_add_f32_dpp v67, v67, v67 quad_perm:[2,3,0,1] row_mask:0xf bank_mask:0xf
    v_bfi_b32 v64, v19, s14, v64
    v_bfi_b32 v65, v19, s28, v65
    v_bfi_b32 v66, v19, s29, v66
    v_bfi_b32 v67, v19, s15, v67
    global_store_dwordx4 v20, v[64:67], s[30:31] sc1
    global_store_dwordx4 v18, v[64:67], s[30:31] sc1
    s_branch L_fin
L_EF:
    v_lshrrev_b32 v22, 1, v2
    s_lshl_b32 s32, s3, 1
    v_add_u32 v22, s32, v22
    v_mul_u32_u24 v21, 256, v22
    v_and_b32 v22, 7, v3
    v_lshl_add_u32 v21, v22, 5, v21
    v_and_b32 v22, 1, v2
    v_lshl_add_u32 v21, v22, 4, v21
    v_lshrrev_b32 v22, 5, v1
    v_lshlrev_b32 v22, 2, v22
    s_lshl_b32 s36, s3, 3
    s_add_u32 s36, s36, 12288
    v_add_u32 v22, s36, v22
    s_sub_u32 s33, s3, 1
    s_cmp_eq_u32 s3, 0
    s_cbranch_scc1 L_E7
    s_mov_b32 s34, s33
    s_lshl_b32 s37, s34, 6
    v_lshl_add_u32 v18, v6, 4, v7
    v_add_u32 v18, s37, v18
    v_mul_u32_u24 v18, 3584, v18
    v_and_b32 v12, 3, v3
    v_lshl_add_u32 v18, v12, 4, v18
    s_lshl_b32 s35, s97, 6
    v_add_u32 v18, s35, v18
    v_and_b32 v12, 4, v3
    v_cmp_eq_u32 vcc, 0, v12
    v_mov_b32 v16, s18
    v_mov_b32 v17, s16
    v_cndmask_b32 v16, v16, v17, vcc
    v_mov_b32 v17, s19
    v_mov_b32 v12, s17
    v_cndmask_b32 v17, v17, v12, vcc
    v_add_co_u32 v16, vcc, v16, v18
    s_nop 1
    v_addc_co_u32 v17, vcc, 0, v17, vcc
    s_movk_i32 s52, 7168
    s_mov_b32 s53, 0
    global_load_dwordx4 v[64:67], v[16:17], off nt
    v_lshl_add_u64 v[16:17], v[16:17], 0, s[52:53]
    global_load_dwordx4 v[68:71], v[16:17], off nt
    v_lshl_add_u64 v[16:17], v[16:17], 0, s[52:53]
    global_load_dwordx4 v[72:75], v[16:17], off nt
    v_lshl_add_u64 v[16:17], v[16:17], 0, s[52:53]
    global_load_dwordx4 v[76:79], v[16:17], off nt
    v_lshl_add_u64 v[16:17], v[16:17], 0, s[52:53]
    global_load_dwordx4 v[80:83], v[16:17], off nt
    v_lshl_add_u64 v[16:17], v[16:17], 0, s[52:53]
    global_load_dwordx4 v[84:87], v[16:17], off nt
    v_lshl_add_u64 v[16:17], v[16:17], 0, s[52:53]
    global_load_dwordx4 v[88:91], v[16:17], off nt
    v_lshl_add_u64 v[16:17], v[16:17], 0, s[52:53]
    global_load_dwordx4 v[92:95], v[16:17], off nt
    s_cmp_gt_u32 s3, 4
    s_cbranch_scc1 L_dn2
    v_lshl_add_u32 v13, v6, 3, v7
    v_mul_u32_u24 v13, 896, v13
    v_add_u32 v13, v13, v8
    s_mul_i32 s35, s97, 28672
    s_lshl_b32 s36, s33, 7
    s_add_u32 s35, s35, s36
    s_add_u32 s54, s20, s35
    s_addc_u32 s55, s21, 0
    s_cmp_eq_u32 s3, 4
    s_cbranch_scc1 L_dn1
    global_load_dwordx4 v[136:139], v13, s[54:55] offset:512 nt
    s_add_u32 s54, s54, 1792
    s_addc_u32 s55, s55, 0
    global_load_dwordx4 v[140:143], v13, s[54:55] offset:512 nt
    s_add_u32 s54, s54, 1792
    s_addc_u32 s55, s55, 0
    global_load_dwordx4 v[144:147], v13, s[54:55] offset:512 nt
    s_add_u32 s54, s54, 1792
    s_addc_u32 s55, s55, 0
    global_load_dwordx4 v[148:151], v13, s[54:55] offset:512 nt
    s_sub_u32 s54, s54, 5376
    s_subb_u32 s55, s55, 0
L_dn1:
    global_load_dwordx4 v[96:99], v13, s[54:55] nt
    s_add_u32 s54, s54, 1792
    s_addc_u32 s55, s55, 0
    global_load_dwordx4 v[100:103], v13, s[54:55] nt
    s_add_u32 s54, s54, 1792
    s_addc_u32 s55, s55, 0
    global_load_dwordx4 v[104:107], v13, s[54:55] nt
    s_add_u32 s54, s54, 1792
    s_addc_u32 s55, s55, 0
    global_load_dwordx4 v[108:111], v13, s[54:55] nt
L_dn2:
    v_lshl_add_u32 v11, v3, 2, v2
    v_add_lshl_u32 v12, v11, s37, 1
    global_load_ushort v20, v12, s[4:5]
    s_lshl_b32 s36, s34, 8
    v_lshl_add_u32 v13, v3, 4, s36
    v_cmp_lt_u32 vcc, 895, v13
    s_nop 1
    v_cndmask_b32 v12, 0, 64, vcc
    v_lshl_add_u32 v13, v12, 1, v13
    v_lshl_add_u32 v15, v2, 13, v13
    v_add_u32 v15, 27136, v15
    v_lshl_add_u32 v14, v2, 11, v13
    s_lshl_b32 s36, s0, 14
    s_add_u32 s36, s36, 1311232
    v_add_u32 v14, s36, v14
    v_add_u32 v13, 8192, v14
    v_mov_b64 v[24:25], 0
    v_mov_b64 v[26:27], 0
    v_mov_b64 v[28:29], 0
    v_mov_b64 v[30:31], 0
    v_mov_b64 v[128:129], 0
    v_mov_b64 v[130:131], 0
    v_mov_b64 v[132:133], 0
    v_mov_b64 v[134:135], 0
    v_mov_b64 v[152:153], 0
    v_mov_b64 v[154:155], 0
    v_bfe_u32 v23, v3, 1, 1
    v_lshrrev_b32 v12, 2, v3
    v_lshl_add_u32 v23, v23, 2, v12
    v_and_b32 v12, 1, v3
    v_lshl_add_u32 v23, v23, 1, v12
    v_lshlrev_b32 v23, 4, v23
    v_lshl_add_u32 v23, v2, 8, v23
    v_lshlrev_b32 v9, 3, v1
    v_mov_b32 v11, 13056
    v_mov_b32 v16, 1
    v_and_b32 v18, 7, v1
    v_lshlrev_b32 v18, 3, v18
    v_add_u32 v18, 12288, v18
    v_lshrrev_b32 v10, 1, v3
    s_lshl_b32 s36, s33, 2
    v_add_u32 v10, s36, v10
    v_lshlrev_b32 v10, 13, v10
    v_and_b32 v12, 1, v3
    v_lshl_add_u32 v10, v12, 5, v10
    v_lshl_add_u32 v10, v2, 4, v10
    s_mul_i32 s36, s97, 37
    s_lshr_b32 s36, s36, 8
    s_add_u32 s36, s36, s97
    s_lshl_b32 s36, s36, 7
    s_add_u32 s36, s36, 131584
    v_add_u32 v10, s36, v10
    v_add_u32 v61, 0x20000, v10
    s_barrier
L_m6_10:
    global_load_dwordx4 v[32:35], v15, s[30:31] offset:-2048 sc1
    global_load_dwordx4 v[36:39], v15, s[30:31] sc1
    global_load_dwordx4 v[40:43], v15, s[30:31] offset:2048 sc1
    s_waitcnt vmcnt(0)
    v_perm_b32 v44, v33, v32, s22
    v_perm_b32 v45, v35, v34, s23
    v_perm_b32 v46, v37, v36, s22
    v_perm_b32 v47, v39, v38, s23
    v_perm_b32 v48, v41, v40, s22
    v_perm_b32 v49, v43, v42, s23
    v_bitop3_b32 v44, v44, v45, s14 bitop3:0x56
    v_bitop3_b32 v46, v46, v47, s14 bitop3:0x56
    v_bitop3_b32 v48, v48, v49, s14 bitop3:0x56
    v_or3_b32 v44, v44, v46, v48
    v_cmp_ne_u32 vcc, 0, v44
    s_cbranch_vccz L_m6o_11
    s_sleep 2
    s_sub_i32 s96, s96, 1
    s_cmp_gt_i32 s96, 0
    s_cbranch_scc1 L_m6_10
L_m6o_11:
    global_load_dwordx4 v[112:115], v14, s[30:31] sc1
    global_load_dwordx4 v[116:119], v13, s[30:31] sc1
    v_permlane32_swap_b32 v32, v34
    v_permlane32_swap_b32 v33, v35
    v_permlane32_swap_b32 v36, v38
    v_permlane32_swap_b32 v37, v39
    v_permlane32_swap_b32 v40, v42
    v_permlane32_swap_b32 v41, v43
    v_add_f32 v32, v32, v34
    v_add_f32 v33, v33, v35
    v_add_f32 v36, v36, v38
    v_add_f32 v37, v37, v39
    v_add_f32 v40, v40, v42
    v_add_f32 v41, v41, v43
    v_permlane16_swap_b32 v32, v33
    v_permlane16_swap_b32 v36, v37
    v_permlane16_swap_b32 v40, v41
    v_add_f32 v32, v32, v33
    v_add_f32 v36, v36, v37
    v_add_f32 v40, v40, v41
    v_cvt_pk_bf16_f32 v56, v32, v32
    v_and_b32 v56, 0xffff0000, v56
    v_cvt_pk_bf16_f32 v58, v40, v40
    v_and_b32 v58, 0xffff0000, v58
    v_add_f32 v58, 1.0, v58
    v_cvt_pk_bf16_f32 v34, v58, 0
    v_cvt_pk_bf16_f32 v36, v36, 0
    v_lshlrev_b32 v58, 16, v34
    v_lshlrev_b32 v20, 16, v20
    v_mov_b32_dpp v35, v34 row_half_mirror row_mask:0xf bank_mask:0xf
    v_mov_b32_dpp v37, v36 row_half_mirror row_mask:0xf bank_mask:0xf
    v_mov_b32_dpp v160, v34 quad_perm:[0,0,0,0] row_mask:0xf bank_mask:0x5
    v_mov_b32_dpp v163, v34 quad_perm:[0,0,0,0] row_mask:0xf bank_mask:0xa
    v_mov_b32_dpp v161, v35 quad_perm:[3,3,3,3] row_mask:0xf bank_mask:0xa
    v_mov_b32_dpp v162, v35 quad_perm:[3,3,3,3] row_mask:0xf bank_mask:0x5
    v_mov_b32_dpp v164, v34 quad_perm:[1,1,1,1] row_mask:0xf bank_mask:0x5
    v_mov_b32_dpp v167, v34 quad_perm:[1,1,1,1] row_mask:0xf bank_mask:0xa
    v_mov_b32_dpp v165, v35 quad_perm:[2,2,2,2] row_mask:0xf bank_mask:0xa
    v_mov_b32_dpp v166, v35 quad_perm:[2,2,2,2] row_mask:0xf bank_mask:0x5
    v_smfmac_f32_16x16x64_bf16 v[128:131], v[160:163], v[64:71], v4
    v_mov_b32_dpp v160, v34 quad_perm:[2,2,2,2] row_mask:0xf bank_mask:0x5
    v_mov_b32_dpp v163, v34 quad_perm:[2,2,2,2] row_mask:0xf bank_mask:0xa
    v_mov_b32_dpp v161, v35 quad_perm:[1,1,1,1] row_mask:0xf bank_mask:0xa
    v_mov_b32_dpp v162, v35 quad_perm:[1,1,1,1] row_mask:0xf bank_mask:0x5
    v_smfmac_f32_16x16x64_bf16 v[128:131], v[164:167], v[72:79], v4
    v_mov_b32_dpp v164, v34 quad_perm:[3,3,3,3] row_mask:0xf bank_mask:0x5
    v_mov_b32_dpp v167, v34 quad_perm:[3,3,3,3] row_mask:0xf bank_mask:0xa
    v_mov_b32_dpp v165, v35 quad_perm:[0,0,0,0] row_mask:0xf bank_mask:0xa
    v_mov_b32_dpp v166, v35 quad_perm:[0,0,0,0] row_mask:0xf bank_mask:0x5
    v_smfmac_f32_16x16x64_bf16 v[128:131], v[160:163], v[80:87], v4
    s_nop 0
    v_smfmac_f32_16x16x64_bf16 v[128:131], v[164:167], v[88:95], v4
    v_mov_b32_dpp v160, v36 quad_perm:[0,0,0,0] row_mask:0xf bank_mask:0x5
    v_mov_b32_dpp v163, v36 quad_perm:[0,0,0,0] row_mask:0xf bank_mask:0xa
    v_mov_b32_dpp v161, v37 quad_perm:[3,3,3,3] row_mask:0xf bank_mask:0xa
    v_mov_b32_dpp v162, v37 quad_perm:[3,3,3,3] row_mask:0xf bank_mask:0x5
    v_mov_b32_dpp v164, v36 quad_perm:[1,1,1,1] row_mask:0xf bank_mask:0x5
    v_mov_b32_dpp v167, v36 quad_perm:[1,1,1,1] row_mask:0xf bank_mask:0xa
    v_mov_b32_dpp v165, v37 quad_perm:[2,2,2,2] row_mask:0xf bank_mask:0xa
    v_mov_b32_dpp v166, v37 quad_perm:[2,2,2,2] row_mask:0xf bank_mask:0x5
    v_smfmac_f32_16x16x64_bf16 v[132:135], v[160:163], v[64:71], v4
    v_mov_b32_dpp v160, v36 quad_perm:[2,2,2,2] row_mask:0xf bank_mask:0x5
    v_mov_b32_dpp v163, v36 quad_perm:[2,2,2,2] row_mask:0xf bank_mask:0xa
    v_mov_b32_dpp v161, v37 quad_perm:[1,1,1,1] row_mask:0xf bank_mask:0xa
    v_mov_b32_dpp v162, v37 quad_perm:[1,1,1,1] row_mask:0xf bank_mask:0x5
    v_smfmac_f32_16x16x64_bf16 v[132:135], v[164:167], v[72:79], v4
    v_mov_b32_dpp v164, v36 quad_perm:[3,3,3,3] row_mask:0xf bank_mask:0x5
    v_mov_b32_dpp v167, v36 quad_perm:[3,3,3,3] row_mask:0xf bank_mask:0xa
    v_mov_b32_dpp v165, v37 quad_perm:[0,0,0,0] row_mask:0xf bank_mask:0xa
    v_mov_b32_dpp v166, v37 quad_perm:[0,0,0,0] row_mask:0xf bank_mask:0x5
    v_smfmac_f32_16x16x64_bf16 v[132:135], v[160:163], v[80:87], v4
    s_nop 0
    v_smfmac_f32_16x16x64_bf16 v[132:135], v[164:167], v[88:95], v4
    s_mov_b32 exec_lo, 0xff00ff
    s_mov_b32 exec_hi, 0xff00ff00
    ds_write_b128 v21, v[128:131] offset:4096
    s_nop 4
    ds_write_b128 v21, v[132:135] offset:8192
    s_mov_b64 exec, -1
    s_mov_b64 exec, 0x1
    ds_add_u32 v11, v16
    s_mov_b64 exec, -1
    v_mov_b32 v134, 0x3b124925
    v_mov_b32 v135, 0x3727c5ac
L_m4_12:
    s_waitcnt vmcnt(0)
    v_perm_b32 v40, v113, v112, s22
    v_perm_b32 v41, v115, v114, s23
    v_perm_b32 v42, v117, v116, s22
    v_perm_b32 v43, v119, v118, s23
    v_bitop3_b32 v40, v40, v41, s14 bitop3:0x56
    v_bitop3_b32 v42, v42, v43, s14 bitop3:0x56
    v_cmp_ne_u32 s[60:61], 0, v40
    v_cmp_ne_u32 s[62:63], 0, v42
    s_or_b64 s[68:69], s[60:61], s[62:63]
    s_cbranch_scc0 L_m4o_13
    s_mov_b64 exec, s[60:61]
    global_load_dwordx4 v[112:115], v14, s[30:31] sc1
    s_mov_b64 exec, s[62:63]
    global_load_dwordx4 v[116:119], v13, s[30:31] sc1
    s_mov_b64 exec, -1
    s_sub_i32 s96, s96, 1
    s_cmp_gt_i32 s96, 0
    s_cbranch_scc1 L_m4_12
    s_waitcnt vmcnt(0)
L_m4o_13:
    v_pk_add_f32 v[32:33], v[112:113], v[116:117]
    v_pk_add_f32 v[34:35], v[114:115], v[118:119]
    s_nop 1
    v_permlane32_swap_b32 v32, v34
    v_permlane32_swap_b32 v33, v35
    v_add_f32 v32, v32, v34
    v_add_f32 v33, v33, v35
    s_nop 1
    v_permlane16_swap_b32 v32, v33
    v_add_f32 v32, v32, v33
    v_fma_f32 v33, v56, v32, v20
    v_mul_f32 v32, v33, v58
    v_mul_f32 v34, v33, v33
    v_and_b32 v35, 0xffff0000, v32
    v_sub_f32 v32, v32, v35
    v_cvt_pk_bf16_f32 v32, v32, v35
    v_permlane32_swap_b32 v33, v34
    s_nop 0
    v_mov_b32_dpp v35, v32 row_half_mirror row_mask:0xf bank_mask:0xf
    v_mov_b32_dpp v160, v32 quad_perm:[0,0,0,0] row_mask:0xf bank_mask:0x5
    v_mov_b32_dpp v163, v32 quad_perm:[0,0,0,0] row_mask:0xf bank_mask:0xa
    v_mov_b32_dpp v161, v35 quad_perm:[3,3,3,3] row_mask:0xf bank_mask:0xa
    v_mov_b32_dpp v162, v35 quad_perm:[3,3,3,3] row_mask:0xf bank_mask:0x5
    v_mov_b32_dpp v164, v32 quad_perm:[1,1,1,1] row_mask:0xf bank_mask:0x5
    v_mov_b32_dpp v167, v32 quad_perm:[1,1,1,1] row_mask:0xf bank_mask:0xa
    v_mov_b32_dpp v165, v35 quad_perm:[2,2,2,2] row_mask:0xf bank_mask:0xa
    v_mov_b32_dpp v166, v35 quad_perm:[2,2,2,2] row_mask:0xf bank_mask:0x5
    v_add_f32 v33, v33, v34
    v_smfmac_f32_16x16x64_bf16 v[24:27], v[160:163], v[64:71], v4
    v_mov_b32_dpp v160, v32 quad_perm:[2,2,2,2] row_mask:0xf bank_mask:0x5
    v_mov_b32_dpp v163, v32 quad_perm:[2,2,2,2] row_mask:0xf bank_mask:0xa
    v_mov_b32_dpp v161, v35 quad_perm:[1,1,1,1] row_mask:0xf bank_mask:0xa
    v_mov_b32_dpp v162, v35 quad_perm:[1,1,1,1] row_mask:0xf bank_mask:0x5
    v_add_f32_dpp v33, v33, v33 quad_perm:[1,0,3,2] row_mask:0xf bank_mask:0xf
    v_smfmac_f32_16x16x64_bf16 v[24:27], v[164:167], v[72:79], v4
    v_mov_b32_dpp v164, v32 quad_perm:[3,3,3,3] row_mask:0xf bank_mask:0x5
    v_mov_b32_dpp v167, v32 quad_perm:[3,3,3,3] row_mask:0xf bank_mask:0xa
    v_mov_b32_dpp v165, v35 quad_perm:[0,0,0,0] row_mask:0xf bank_mask:0xa
    v_mov_b32_dpp v166, v35 quad_perm:[0,0,0,0] row_mask:0xf bank_mask:0x5
    v_add_f32_dpp v33, v33, v33 quad_perm:[2,3,0,1] row_mask:0xf bank_mask:0xf
    v_smfmac_f32_16x16x64_bf16 v[24:27], v[160:163], v[80:87], v4
    v_smfmac_f32_16x16x64_bf16 v[24:27], v[164:167], v[88:95], v4
    v_add_f32_dpp v33, v33, v33 row_half_mirror row_mask:0xf bank_mask:0xf
    s_nop 1
    v_add_f32_dpp v33, v33, v33 row_mirror row_mask:0xf bank_mask:0xf
    s_nop 1
    v_add_f32_dpp v33, v33, v33 row_bcast:15 row_mask:0xa bank_mask:0xf
    s_mov_b32 exec_lo, 0xff00ff
    s_mov_b32 exec_hi, 0xff00ff00
    ds_write_b128 v21, v[24:27] offset:0
    s_mov_b32 exec_lo, 0x10000
    s_mov_b32 exec_hi, 0x10000
    ds_write_b32 v22, v33
    s_mov_b64 exec, -1
    s_waitcnt lgkmcnt(0)
    s_barrier
    s_cmp_gt_u32 s3, 4
    s_cbranch_scc1 L_fin
    ds_read_b64 v[48:49], v18
    ds_read_b128 v[32:35], v23 offset:0
    ds_read_b128 v[36:39], v23 offset:1024
    ds_read_b128 v[40:43], v23 offset:2048
    ds_read_b128 v[44:47], v23 offset:3072
    ds_read_b64 v[132:133], v9 offset:12544
    s_waitcnt lgkmcnt(5)
    v_add_f32_dpp v48, v48, v48 quad_perm:[1,0,3,2] row_mask:0xf bank_mask:0xf
    v_add_f32_dpp v49, v49, v49 quad_perm:[1,0,3,2] row_mask:0xf bank_mask:0xf
    s_nop 0
    v_add_f32_dpp v48, v48, v48 quad_perm:[2,3,0,1] row_mask:0xf bank_mask:0xf
    v_add_f32_dpp v49, v49, v49 quad_perm:[2,3,0,1] row_mask:0xf bank_mask:0xf
    s_nop 0
    v_add_f32_dpp v48, v48, v48 row_half_mirror row_mask:0xf bank_mask:0xf
    v_add_f32_dpp v49, v49, v49 row_half_mirror row_mask:0xf bank_mask:0xf
    v_mul_f32 v48, v48, v134
    v_fma_f32 v49, v49, v134, v135
    v_fma_f32 v49, -v48, v48, v49
    v_max_f32 v49, v135, v49
    v_rsq_f32 v49, v49
    s_waitcnt lgkmcnt(3)
    v_pk_add_f32 v[32:33], v[32:33], v[36:37]
    v_pk_add_f32 v[34:35], v[34:35], v[38:39]
    s_waitcnt lgkmcnt(1)
    v_pk_add_f32 v[40:41], v[40:41], v[44:45]
    v_pk_add_f32 v[42:43], v[42:43], v[46:47]
    v_pk_add_f32 v[32:33], v[32:33], v[40:41]
    v_pk_add_f32 v[34:35], v[34:35], v[42:43]
    s_nop 1
    v_permlane32_swap_b32 v32, v34
    v_permlane32_swap_b32 v33, v35
    v_add_f32 v32, v32, v34
    v_add_f32 v33, v33, v35
    s_nop 1
    v_permlane16_swap_b32 v32, v33
    v_add_f32 v32, v32, v33
    s_waitcnt lgkmcnt(0)
    v_fma_f32 v32, -v48, v132, v32
    v_fma_f32 v32, v32, v49, v133
    v_mul_f32 v33, v32, v32
    v_mov_b32 v34, 0xc0135761
    v_mov_b32_dpp v35, v32 quad_perm:[2,3,2,3] row_mask:0xf bank_mask:0xf
    v_fmamk_f32 v33, v33, 0xbdd2d3e8, v34
    v_mul_f32 v33, v33, v32
    v_exp_f32 v33, v33
    v_mul_f32 v32, v32, v35
    v_add_f32 v33, 1.0, v33
    v_rcp_f32 v33, v33
    s_nop 0
    v_mul_f32 v32, v32, v33
    v_cvt_pk_bf16_f32 v32, v32, 0
    s_nop 1
    v_mov_b32_dpp v33, v32 row_half_mirror row_mask:0xf bank_mask:0xf
    v_mov_b32_dpp v160, v32 quad_perm:[0,0,0,0] row_mask:0xf bank_mask:0x5
    v_mov_b32_dpp v163, v32 quad_perm:[0,0,0,0] row_mask:0xf bank_mask:0xa
    v_mov_b32_dpp v161, v33 quad_perm:[3,3,3,3] row_mask:0xf bank_mask:0xa
    v_mov_b32_dpp v162, v33 quad_perm:[3,3,3,3] row_mask:0xf bank_mask:0x5
    v_mov_b32_dpp v164, v32 quad_perm:[1,1,1,1] row_mask:0xf bank_mask:0x5
    v_mov_b32_dpp v167, v32 quad_perm:[1,1,1,1] row_mask:0xf bank_mask:0xa
    v_mov_b32_dpp v165, v33 quad_perm:[2,2,2,2] row_mask:0xf bank_mask:0xa
    v_mov_b32_dpp v166, v33 quad_perm:[2,2,2,2] row_mask:0xf bank_mask:0x5
    v_smfmac_f32_16x16x64_bf16 v[28:31], v[160:163], v[96:103], v4
    v_smfmac_f32_16x16x64_bf16 v[152:155], v[160:163], v[136:143], v4
    v_smfmac_f32_16x16x64_bf16 v[28:31], v[164:167], v[104:111], v4
    v_smfmac_f32_16x16x64_bf16 v[152:155], v[164:167], v[144:151], v4
    s_cmp_eq_u32 s3, 4
    s_nop 5
    v_permlane32_swap_b32 v28, v36
    v_permlane32_swap_b32 v29, v37
    v_permlane32_swap_b32 v30, v38
    v_permlane32_swap_b32 v31, v39
    v_add_f32_dpp v28, v36, v28 row_ror:8 row_mask:0xf bank_mask:0xf
    v_add_f32_dpp v29, v37, v29 row_ror:8 row_mask:0xf bank_mask:0xf
    v_add_f32_dpp v30, v38, v30 row_ror:8 row_mask:0xf bank_mask:0xf
    v_add_f32_dpp v31, v39, v31 row_ror:8 row_mask:0xf bank_mask:0xf
    v_bfi_b32 v28, v19, s14, v28
    v_bfi_b32 v29, v19, s28, v29
    v_bfi_b32 v30, v19, s29, v30
    v_bfi_b32 v31, v19, s15, v31
    s_mov_b64 exec, 0xff00ff
    global_store_dwordx4 v10, v[28:31], s[30:31] sc1
    s_mov_b64 exec, -1
    s_cbranch_scc1 L_fin
    v_permlane32_swap_b32 v152, v40
    v_permlane32_swap_b32 v153, v41
    v_permlane32_swap_b32 v154, v42
    v_permlane32_swap_b32 v155, v43
    v_add_f32_dpp v152, v40, v152 row_ror:8 row_mask:0xf bank_mask:0xf
    v_add_f32_dpp v153, v41, v153 row_ror:8 row_mask:0xf bank_mask:0xf
    v_add_f32_dpp v154, v42, v154 row_ror:8 row_mask:0xf bank_mask:0xf
    v_add_f32_dpp v155, v43, v155 row_ror:8 row_mask:0xf bank_mask:0xf
    v_bfi_b32 v152, v19, s14, v152
    v_bfi_b32 v153, v19, s28, v153
    v_bfi_b32 v154, v19, s29, v154
    v_bfi_b32 v155, v19, s15, v155
    s_mov_b64 exec, 0xff00ff
    global_store_dwordx4 v61, v[152:155], s[30:31] sc1
    s_mov_b64 exec, -1
    s_branch L_fin
L_E7:
    v_mov_b32 v24, 0
    v_mov_b32 v25, 0
    v_mov_b32 v26, 0
    v_mov_b32 v27, 0
    ds_write_b32 v22, v24
    s_mov_b32 exec_lo, 0xff00ff
    s_mov_b32 exec_hi, 0xff00ff00
    ds_write_b128 v21, v[24:27] offset:0
    ds_write_b128 v21, v[24:27] offset:4096
    ds_write_b128 v21, v[24:27] offset:8192
    s_mov_b64 exec, -1
    v_bfe_u32 v23, v3, 1, 1
    v_lshrrev_b32 v12, 2, v3
    v_lshl_add_u32 v23, v23, 2, v12
    v_and_b32 v12, 1, v3
    v_lshl_add_u32 v23, v23, 1, v12
    v_lshlrev_b32 v23, 4, v23
    v_lshl_add_u32 v23, v2, 8, v23
    v_lshlrev_b32 v9, 3, v1
    v_mov_b32 v11, 13056
    s_barrier
L_uc_14:
    ds_read_b32 v16, v11
    s_waitcnt lgkmcnt(0)
    v_cmp_ne_u32 vcc, 7, v16
    s_cbranch_vccz L_uco_15
    s_sleep 2
    s_sub_i32 s96, s96, 1
    s_cmp_gt_i32 s96, 0
    s_cbranch_scc1 L_uc_14
L_uco_15:
    ds_read_b128 v[32:35], v23 offset:4096
    ds_read_b128 v[36:39], v23 offset:5120
    ds_read_b128 v[40:43], v23 offset:6144
    ds_read_b128 v[44:47], v23 offset:7168
    ds_read_b128 v[112:115], v23 offset:8192
    ds_read_b128 v[116:119], v23 offset:9216
    ds_read_b128 v[120:123], v23 offset:10240
    ds_read_b128 v[124:127], v23 offset:11264
    s_waitcnt lgkmcnt(0)
    v_pk_add_f32 v[32:33], v[32:33], v[36:37]
    v_pk_add_f32 v[34:35], v[34:35], v[38:39]
    v_pk_add_f32 v[40:41], v[40:41], v[44:45]
    v_pk_add_f32 v[42:43], v[42:43], v[46:47]
    v_pk_add_f32 v[32:33], v[32:33], v[40:41]
    v_pk_add_f32 v[34:35], v[34:35], v[42:43]
    v_pk_add_f32 v[112:113], v[112:113], v[116:117]
    v_pk_add_f32 v[114:115], v[114:115], v[118:119]
    v_pk_add_f32 v[120:121], v[120:121], v[124:125]
    v_pk_add_f32 v[122:123], v[122:123], v[126:127]
    v_pk_add_f32 v[112:113], v[112:113], v[120:121]
    v_pk_add_f32 v[114:115], v[114:115], v[122:123]
    v_permlane32_swap_b32 v32, v34
    v_permlane32_swap_b32 v33, v35
    v_permlane32_swap_b32 v112, v114
    v_permlane32_swap_b32 v113, v115
    v_add_f32 v32, v32, v34
    v_add_f32 v33, v33, v35
    v_add_f32 v112, v112, v114
    v_add_f32 v113, v113, v115
    v_permlane16_swap_b32 v32, v33
    s_nop 0
    v_permlane16_swap_b32 v112, v113
    v_add_f32 v32, v32, v33
    v_add_f32 v112, v112, v113
    v_mov_b32 v33, v112
    ds_write_b64 v9, v[32:33] offset:12544
    s_waitcnt lgkmcnt(0)
    s_barrier
    s_branch L_fin
L_G:
    v_and_b32 v10, 3, v1
    v_lshrrev_b32 v11, 2, v1
    s_lshl_b32 s34, s1, 4
    v_lshl_add_u32 v12, v10, 2, s34
    v_add_lshl_u32 v13, v12, v2, 1
    global_load_ushort v20, v13, s[4:5]
    s_cmp_ge_u32 s1, 14
    s_cselect_b32 s36, 128, 0
    v_lshl_add_u32 v14, v12, 2, s36
    v_and_b32 v16, 3, v11
    v_lshl_add_u32 v16, v16, 13, v14
    v_add_u32 v16, 25088, v16
    v_add_u32 v15, 6144, v16
    v_and_b32 v17, 7, v11
    v_min_u32 v18, 6, v17
    v_cmp_gt_u32 vcc, 7, v17
    s_nop 1
    v_cndmask_b32 v22, 0, 1.0, vcc
    v_lshl_add_u32 v17, v17, 11, v14
    s_lshl_b32 s35, s0, 14
    s_add_u32 s35, s35, 1311232
    v_add_u32 v17, s35, v17
    s_lshl_b32 s35, s1, 13
    s_add_u32 s35, s35, 135680
    v_lshlrev_b32 v18, 7, v18
    v_lshl_add_u32 v18, v10, 4, v18
    v_lshrrev_b32 v19, 5, v1
    v_lshl_add_u32 v18, v19, 10, v18
    v_add_u32 v18, s35, v18
    s_mov_b32 s72, 0xffff0000
    s_mov_b32 s73, 0
    s_mov_b32 s74, 0
    s_mov_b32 s75, 0xffff
    s_mov_b32 s76, 0
    s_mov_b32 s77, 0xffff0000
    global_load_dwordx4 v[32:35], v16, s[30:31] sc1
    global_load_dwordx4 v[44:47], v17, s[30:31] sc1
L_g46_16:
    s_waitcnt vmcnt(0)
    v_perm_b32 v48, v33, v32, s22
    v_perm_b32 v49, v35, v34, s23
    v_perm_b32 v50, v45, v44, s22
    v_perm_b32 v51, v47, v46, s23
    v_bitop3_b32 v48, v48, v49, s14 bitop3:0x56
    v_bitop3_b32 v50, v50, v51, s14 bitop3:0x56
    v_cmp_ne_u32 s[60:61], 0, v48
    v_cmp_ne_u32 s[62:63], 0, v50
    s_or_b64 s[68:69], s[60:61], s[62:63]
    s_cbranch_scc0 L_g46o_17
    s_sleep 4
    s_mov_b64 exec, s[60:61]
    global_load_dwordx4 v[32:35], v16, s[30:31] sc1
    s_mov_b64 exec, s[62:63]
    global_load_dwordx4 v[44:47], v17, s[30:31] sc1
    s_mov_b64 exec, -1
    s_sub_i32 s96, s96, 1
    s_cmp_gt_i32 s96, 0
    s_cbranch_scc1 L_g46_16
    s_waitcnt vmcnt(0)
L_g46o_17:
    global_load_dwordx4 v[64:67], v18, s[30:31] offset:-4096 sc1
    global_load_dwordx4 v[68:71], v18, s[30:31] offset:-2048 sc1
    global_load_dwordx4 v[72:75], v18, s[30:31] offset:0 sc1
    global_load_dwordx4 v[76:79], v18, s[30:31] offset:2048 sc1
    global_load_dwordx4 v[40:43], v15, s[30:31] sc1
    v_cndmask_b32 v32, v32, v33, s[72:73]
    v_cndmask_b32 v32, v32, v34, s[74:75]
    v_cndmask_b32 v32, v32, v35, s[76:77]
    s_nop 1
    v_add_f32_dpp v32, v32, v32 row_ror:8 row_mask:0xf bank_mask:0xf
    s_nop 1
    v_add_f32_dpp v32, v32, v32 row_ror:4 row_mask:0xf bank_mask:0xf
    v_cvt_pk_bf16_f32 v56, v32, v32
    v_and_b32 v56, 0xffff0000, v56
    v_lshlrev_b32 v20, 16, v20
    v_permlane32_swap_b32 v44, v46
    v_permlane32_swap_b32 v45, v47
    v_add_f32 v44, v44, v46
    v_add_f32 v45, v45, v47
    s_nop 1
    v_permlane16_swap_b32 v44, v45
    v_add_f32 v44, v44, v45
    s_nop 1
    v_add_f32_dpp v44, v44, v44 row_ror:8 row_mask:0xf bank_mask:0xf
    s_nop 1
    v_add_f32_dpp v44, v44, v44 row_ror:4 row_mask:0xf bank_mask:0xf
    v_mul_f32 v44, 0.5, v44
    v_cvt_pk_bf16_f32 v32, v44, v44
    v_and_b32 v32, 0xffff0000, v32
    v_mul_f32 v32, v56, v32
    v_cvt_pk_bf16_f32 v32, v32, v32
    v_and_b32 v32, 0xffff0000, v32
    v_add_f32 v20, v20, v32
    v_cvt_pk_bf16_f32 v20, v20, v20
    v_and_b32 v20, 0xffff0000, v20
    v_mov_b32 v58, 17408
    v_mov_b32 v59, s14
    global_load_dwordx4 v[64:67], v18, s[30:31] offset:-4096 sc1
    global_load_dwordx4 v[68:71], v18, s[30:31] offset:-2048 sc1
    global_load_dwordx4 v[72:75], v18, s[30:31] offset:0 sc1
    global_load_dwordx4 v[76:79], v18, s[30:31] offset:2048 sc1
    global_load_dwordx4 v[40:43], v15, s[30:31] sc1
L_g5_18:
    s_waitcnt vmcnt(5)
    v_perm_b32 v48, v65, v64, s22
    v_perm_b32 v49, v67, v66, s23
    v_perm_b32 v50, v69, v68, s22
    v_perm_b32 v51, v71, v70, s23
    v_perm_b32 v52, v73, v72, s22
    v_perm_b32 v53, v75, v74, s23
    v_perm_b32 v54, v77, v76, s22
    v_perm_b32 v55, v79, v78, s23
    v_perm_b32 v56, v41, v40, s22
    v_perm_b32 v57, v43, v42, s23
    v_bitop3_b32 v48, v48, v49, s14 bitop3:0x56
    v_bitop3_b32 v50, v50, v51, s14 bitop3:0x56
    v_bitop3_b32 v52, v52, v53, s14 bitop3:0x56
    v_bitop3_b32 v54, v54, v55, s14 bitop3:0x56
    v_bitop3_b32 v56, v56, v57, s14 bitop3:0x56
    v_cmp_ne_u32 s[60:61], 0, v48
    v_cmp_ne_u32 s[62:63], 0, v50
    v_cmp_ne_u32 s[64:65], 0, v52
    v_cmp_ne_u32 s[66:67], 0, v54
    v_cmp_ne_u32 s[68:69], 0, v56
    s_or_b64 s[70:71], s[60:61], s[62:63]
    s_or_b64 s[70:71], s[70:71], s[64:65]
    s_or_b64 s[70:71], s[70:71], s[66:67]
    s_or_b64 s[70:71], s[70:71], s[68:69]
    s_cbranch_scc0 L_g5o_19
    s_mov_b64 exec, s[60:61]
    global_load_dwordx4 v[64:67], v18, s[30:31] offset:-4096 sc1
    s_mov_b64 exec, s[62:63]
    global_load_dwordx4 v[68:71], v18, s[30:31] offset:-2048 sc1
    s_mov_b64 exec, s[64:65]
    global_load_dwordx4 v[72:75], v18, s[30:31] offset:0 sc1
    s_mov_b64 exec, s[66:67]
    global_load_dwordx4 v[76:79], v18, s[30:31] offset:2048 sc1
    s_mov_b64 exec, s[68:69]
    global_load_dwordx4 v[40:43], v15, s[30:31] sc1
    s_mov_b64 exec, -1
    s_sub_i32 s96, s96, 1
    s_cmp_gt_i32 s96, 0
    s_cbranch_scc1 L_g5_18
    s_waitcnt vmcnt(0)
L_g5o_19:
    v_pk_add_f32 v[32:33], v[64:65], v[68:69]
    v_pk_add_f32 v[34:35], v[66:67], v[70:71]
    v_pk_add_f32 v[36:37], v[72:73], v[76:77]
    v_pk_add_f32 v[38:39], v[74:75], v[78:79]
    v_cndmask_b32 v60, v40, v41, s[72:73]
    v_pk_add_f32 v[32:33], v[32:33], v[36:37]
    v_pk_add_f32 v[34:35], v[34:35], v[38:39]
    v_cndmask_b32 v60, v60, v42, s[74:75]
    v_pk_mul_f32 v[32:33], v[32:33], v[22:23] op_sel_hi:[1,0]
    v_pk_mul_f32 v[34:35], v[34:35], v[22:23] op_sel_hi:[1,0]
    v_cndmask_b32 v60, v60, v43, s[76:77]
    s_nop 0
    v_permlane32_swap_b32 v32, v34
    v_permlane32_swap_b32 v33, v35
    v_add_f32_dpp v60, v60, v60 row_ror:8 row_mask:0xf bank_mask:0xf
    v_add_f32 v32, v32, v34
    v_add_f32 v33, v33, v35
    v_add_f32_dpp v60, v60, v60 row_ror:4 row_mask:0xf bank_mask:0xf
    s_nop 0
    v_permlane16_swap_b32 v32, v33
    v_add_f32 v32, v32, v33
    v_cvt_pk_bf16_f32 v57, v60, v60
    s_nop 0
    v_add_f32_dpp v32, v32, v32 row_ror:8 row_mask:0xf bank_mask:0xf
    v_and_b32 v57, 0xffff0000, v57
    s_nop 0
    v_add_f32_dpp v32, v32, v32 row_ror:4 row_mask:0xf bank_mask:0xf
    v_fma_f32 v32, v57, v32, v20
    v_cvt_pk_bf16_f32 v32, v32, v32
    s_mov_b32 exec_lo, 0xf000f
    s_mov_b32 exec_hi, 0xf000f
    global_store_short v13, v32, s[26:27]
    s_cmp_lg_u32 s1, 0
    s_cbranch_scc1 L_Gne
    s_mov_b64 exec, 0x1
    global_store_dword v58, v59, s[30:31] sc1
L_Gne:
    s_mov_b64 exec, -1
    s_endpgm
L_Hidle:
    s_waitcnt lgkmcnt(0)
    s_cmp_eq_u32 s1, 7
    s_cbranch_scc1 L_H7
    s_and_b32 s36, s3, 6
    s_cmp_lg_u32 s36, 2
    s_cbranch_scc1 L_Hi2
    s_lshl_b32 s36, s0, 2
    s_lshr_b32 s36, 0x54321054, s36
    s_and_b32 s36, s36, 7
    s_sub_u32 s36, s1, s36
    s_bitcmp1_b32 s0, 0
    s_cselect_b32 s37, 0, 6
    s_cmp_eq_u32 s1, s37
    s_cselect_b32 s36, 0, s36
    s_cmp_lt_u32 s36, 2
    s_cbranch_scc1 L_Hi2
    s_cmp_gt_i32 s36, 0
    s_cselect_b32 s36, 2, 0
    s_sub_u32 s36, s1, s36
    s_and_b32 s37, s0, 1
    s_sub_u32 s36, s36, s37
    s_lshl_b32 s36, s36, 1
    s_lshl3_add_u32 s36, s37, s36
    s_add_u32 s36, s36, s3
    s_add_u32 s35, s36, 12
    s_branch L_mod
L_Hi2:
    s_load_dword s14, s[30:31], 17408
    v_and_b32 v4, 3, v0
    v_mul_u32_u24 v4, 0x5555, v4
    v_mov_b64 v[160:161], 0
    v_mov_b64 v[162:163], 0
    v_mov_b64 v[164:165], 0
    v_mov_b64 v[166:167], 0
    s_waitcnt lgkmcnt(0)
    s_add_u32 s14, s14, 0x01010101
    s_lshr_b32 s28, s14, 8
    s_lshr_b32 s29, s14, 16
    s_lshr_b32 s15, s14, 24
    s_mov_b32 s22, 0x0c0c0400
    s_mov_b32 s23, 0x04000c0c
    v_mov_b32 v19, 0xff
    v_mov_b32 v11, 13056
    ds_write_b64 v11, v[160:161]
    s_waitcnt lgkmcnt(0)
    s_branch L_Hb1
L_H7:
    s_lshl3_add_u32 s36, s0, s3
    s_lshl_b32 s36, s36, 13
    s_add_u32 s36, s36, 6291456
    v_lshrrev_b32 v40, 1, v1
    v_min_u32 v40, 15, v40
    v_lshl_add_u32 v40, v40, 9, s36
    v_and_b32 v41, 1, v1
    v_lshl_add_u32 v40, v41, 7, v40
    global_load_dword v63, v40, s[30:31]
    s_load_dword s14, s[30:31], 17408
    s_mov_b32 s59, 1
    s_waitcnt lgkmcnt(0)
    s_barrier
    s_cmp_lt_u32 s3, 2
    s_cbranch_scc1 L_fin
    s_and_b32 s37, s0, 1
    s_mul_i32 s36, s37, 3
    s_add_u32 s35, s36, s3
    s_add_u32 s35, s35, 28
    s_add_u32 s36, s37, s3
    s_cmp_lt_u32 s36, 5
    s_cbranch_scc1 L_mod
    s_add_u32 s35, s35, 2
    s_add_u32 s35, s35, s37
    s_barrier
    s_branch L_mod
    s_branch L_fin
L_exit:
    s_endpgm
L_end:
    s_endpgm
.section .rodata,"a"
.p2align 6
.amdhsa_kernel adaLN_cond__sliding_block_cached__geglu_ffn__decode_kernel
  .amdhsa_next_free_vgpr 168
  .amdhsa_next_free_sgpr 102
  .amdhsa_accum_offset 168
  .amdhsa_group_segment_fixed_size 0
  .amdhsa_kernarg_size 112
  .amdhsa_user_sgpr_count 2
  .amdhsa_user_sgpr_kernarg_segment_ptr 1
  .amdhsa_system_sgpr_workgroup_id_x 1
  .amdhsa_float_denorm_mode_32 3
.end_amdhsa_kernel
```
